```python
import torch

def _softmax(x, axis=-1):
    return torch.softmax(x, dim=axis)
def _gelu(x):
    return torch.nn.functional.gelu(x, approximate="tanh")
def _silu(x):
    return torch.nn.functional.silu(x)
def _sigmoid(x):
    return torch.sigmoid(x)
def _layernorm(x, axis=-1, eps=1e-5):
    m = x.mean(dim=axis, keepdim=True)
    v = x.var(dim=axis, keepdim=True, unbiased=False)
    return (x - m) / torch.sqrt(v + eps)
def _scatter_add(tgt, idx, src, axis=0):
    return tgt.clone().index_add_(axis, idx, src)
def _segment_sum(src, seg, n):
    out = torch.zeros((n,) + src.shape[1:], dtype=src.dtype)
    return out.index_add_(0, seg, src)
def _pad(x, pw):
    flat = tuple(v for pair in reversed(pw) for v in pair)
    return torch.nn.functional.pad(x, flat)

kernel_name = 'standalone__self_sup_conv_stem_hubert__speech'

def setup_inputs():

    _w = (lambda a: (lambda t: t.to(torch.bfloat16) if t.is_floating_point() else t)(torch.as_tensor(a)))
    B, T, D, K = 2, 16000, 256, 15
    scale = (1.0 / (K * D)) ** 0.5
    return {
        "x": _w((lambda *s: torch.randn(*s, dtype=torch.bfloat16) * 0.05)(B, T, D)),
        "w": _w((lambda *s: torch.randn(*s, dtype=torch.bfloat16) * 0.05)(K, D, D) * scale),
        "b": _w((lambda *s: torch.randn(*s, dtype=torch.bfloat16) * 0.05)(D) * 0.1),
        "gamma": _w(torch.ones((D,), dtype=float)),
        "beta": _w(torch.zeros((D,), dtype=float)),
    }

def reference(x, w, b, gamma, beta):
    B, T, D = x.shape
    K = w.shape[0]
    s = 2
    L = (T - K) // s + 1
    y = torch.einsum('blc,cd->bld', x[:, 0 : s * L : s, :], w[0])
    for i in range(1, K):
        y = y + torch.einsum('blc,cd->bld', x[:, i : i + s * L : s, :], w[i])
    y = y + b[None, None, :]
    mu = y.mean(1, keepdims=True)
    var = ((y - mu) ** 2).mean(1, keepdims=True)
    yn = (y - mu) / torch.sqrt(var + 1e-5)
    yn = yn * gamma[None, None, :] + beta[None, None, :]
    return _gelu(yn)
```

```asm
; @launch grid=(256,1,1) block=(512,1,1) lds=148608
.amdgcn_target "amdgcn-amd-amdhsa--gfx950"
.text
.globl standalone__self_sup_conv_stem_hubert__speech_kernel
.p2align 8
.type standalone__self_sup_conv_stem_hubert__speech_kernel,@function
standalone__self_sup_conv_stem_hubert__speech_kernel:
    s_cmp_ge_u32 s2, 256
    s_cbranch_scc1 L_end
    s_load_dwordx16 s[4:19], s[0:1], 0
    s_getpc_b64 s[44:45]
L_pc0:
    s_mov_b32 s46, L_end - L_pc0
    s_mov_b32 s47, 0x20000
    s_lshr_b32 s56, s2, 3
    s_mul_i32 s56, s56, 768
    v_lshl_add_u32 v1, v0, 7, s56
    v_cmp_gt_u32 vcc, 6, v0
    s_and_saveexec_b64 s[56:57], vcc
    s_cbranch_execz L_nopf
    buffer_load_dword v255, v1, s[44:47], 0 offen
L_nopf:
    s_mov_b64 exec, s[56:57]
    v_lshrrev_b32 v1, 6, v0
    v_and_b32 v0, 63, v0
    v_readfirstlane_b32 s3, v1
    s_lshr_b32 s57, s2, 3
    s_and_b32 s54, s57, 3
    s_lshr_b32 s47, s2, 5
    s_and_b32 s56, s2, 7
    s_lshl_b32 s58, s56, 3
    s_add_u32 s58, s58, s47
    s_lshr_b32 s52, s58, 5
    s_and_b32 s53, s58, 31
    s_mul_i32 s55, s53, 250
    s_lshl_b32 s51, s54, 7
    s_and_b32 s50, s3, 3
    s_lshl_b32 s59, s50, 10
    s_add_u32 s59, s59, 82560
    s_mov_b32 s58, 0xffff0000
    s_cmp_lt_u32 s3, 4
    s_cbranch_scc1 L_compute
    s_mov_b32 s66, 0x35221100
    s_mov_b32 s67, 0x77625744
    v_lshrrev_b32 v20, 3, v0
    v_and_b32 v21, 7, v0
    v_lshlrev_b32 v22, 2, v20
    v_lshrrev_b32 v23, v22, s66
    v_lshrrev_b32 v24, v22, s67
    v_and_b32 v23, 7, v23
    v_and_b32 v24, 7, v24
    v_xor_b32 v23, v23, v21
    v_xor_b32 v24, v24, v21
    s_lshr_b32 s56, s50, 1
    s_lshl_b32 s56, s56, 10
    s_and_b32 s57, s50, 1
    s_lshl_b32 s57, s57, 13
    s_add_u32 s56, s56, s57
    v_lshl_add_u32 v22, v20, 14, s56
    v_lshl_add_u32 v2, v23, 4, v22
    v_lshl_add_u32 v24, v24, 4, v22
    v_add_u32 v3, 131072, v24
    v_lshlrev_b32 v18, 4, v0
    v_add_u32 v18, 262144, v18
    s_lshl_b32 s56, s50, 13
    s_add_u32 s57, s54, 3
    s_and_b32 s57, s57, 3
    s_lshl_b32 s57, s57, 11
    v_add_u32 v9, s57, v3
    v_add_u32 v8, s57, v2
    s_add_u32 s69, s56, s57
    s_cmp_lg_u32 s69, 0
    s_cselect_b32 s57, 128, 0
    s_add_u32 s69, s69, s57
    s_add_u32 s57, s54, 2
    s_and_b32 s57, s57, 3
    s_lshl_b32 s57, s57, 11
    v_add_u32 v7, s57, v3
    v_add_u32 v6, s57, v2
    s_add_u32 s68, s56, s57
    s_cmp_lg_u32 s68, 0
    s_cselect_b32 s57, 128, 0
    s_add_u32 s68, s68, s57
    s_add_u32 s57, s54, 1
    s_and_b32 s57, s57, 3
    s_lshl_b32 s57, s57, 11
    v_add_u32 v5, s57, v3
    v_add_u32 v4, s57, v2
    s_add_u32 s67, s56, s57
    s_cmp_lg_u32 s67, 0
    s_cselect_b32 s57, 128, 0
    s_add_u32 s67, s67, s57
    s_add_u32 s57, s54, 0
    s_and_b32 s57, s57, 3
    s_lshl_b32 s57, s57, 11
    v_add_u32 v3, s57, v3
    v_add_u32 v2, s57, v2
    s_add_u32 s66, s56, s57
    s_cmp_lg_u32 s66, 0
    s_cselect_b32 s57, 128, 0
    s_add_u32 s66, s66, s57
    s_mov_b32 s65, 0
    s_mov_b32 s64, 128
    s_mul_i32 s56, s52, 8192000
    s_lshl_b32 s57, s55, 10
    s_add_u32 s56, s56, s57
    s_sub_u32 s22, 16384000, s56
    s_mov_b32 s23, 0x20000
    s_waitcnt lgkmcnt(0)
    s_add_u32 s20, s4, s56
    s_addc_u32 s21, s5, 0
    s_add_u32 m0, s66, 0
    s_nop 0
    buffer_load_dwordx4 v2, s[20:23], s65 offen nt lds
    s_add_u32 m0, s66, 1024
    s_nop 0
    buffer_load_dwordx4 v3, s[20:23], s65 offen nt lds
    s_add_u32 m0, s67, 0
    s_nop 0
    buffer_load_dwordx4 v4, s[20:23], s65 offen nt lds
    s_add_u32 m0, s67, 1024
    s_nop 0
    buffer_load_dwordx4 v5, s[20:23], s65 offen nt lds
    s_branch L_helper
L_compute:
    v_lshrrev_b32 v15, 3, v0
    s_lshl_b32 s56, s50, 3
    v_add_u32 v1, s56, v15
    v_bfe_u32 v15, v0, 4, 1
    s_and_b32 s56, s50, 1
    s_lshl_b32 s56, s56, 1
    v_or_b32 v15, s56, v15
    v_lshlrev_b32 v15, 1, v15
    v_and_b32 v14, 7, v0
    v_xor_b32 v15, v15, v14
    v_lshlrev_b32 v15, 4, v15
    v_lshl_add_u32 v10, v1, 9, v15
    s_sub_u32 s26, 1966080, s51
    s_mov_b32 s27, 0x20000
    s_waitcnt lgkmcnt(0)
    s_add_u32 s24, s6, s51
    s_addc_u32 s25, s7, 0
    s_add_u32 s56, s47, 0
    s_and_b32 s56, s56, 7
    s_lshl_b32 s57, s56, 12
    s_add_u32 s57, s57, s59
    s_add_u32 m0, s57, 0
    s_lshl_b32 s57, s56, 18
    s_add_u32 s57, s57, 0
    buffer_load_dwordx4 v10, s[24:27], s57 offen lds
    s_add_u32 s56, s47, 1
    s_and_b32 s56, s56, 7
    s_lshl_b32 s57, s56, 12
    s_add_u32 s57, s57, s59
    s_add_u32 m0, s57, 0
    s_lshl_b32 s57, s56, 18
    s_add_u32 s57, s57, 0
    buffer_load_dwordx4 v10, s[24:27], s57 offen lds
    s_add_u32 s56, s47, 2
    s_and_b32 s56, s56, 7
    s_lshl_b32 s57, s56, 12
    s_add_u32 s57, s57, s59
    s_add_u32 m0, s57, 0
    s_lshl_b32 s57, s56, 18
    s_add_u32 s57, s57, 0
    buffer_load_dwordx4 v10, s[24:27], s57 offen lds
    s_add_u32 s56, s47, 3
    s_and_b32 s56, s56, 7
    s_lshl_b32 s57, s56, 12
    s_add_u32 s57, s57, s59
    s_add_u32 m0, s57, 0
    s_lshl_b32 s57, s56, 18
    s_add_u32 s57, s57, 0
    buffer_load_dwordx4 v10, s[24:27], s57 offen lds
    s_add_u32 s56, s47, 0
    s_and_b32 s56, s56, 7
    s_lshl_b32 s57, s56, 12
    s_add_u32 s57, s57, s59
    s_add_u32 m0, s57, 32768
    s_lshl_b32 s57, s56, 18
    s_add_u32 s57, s57, 16384
    buffer_load_dwordx4 v10, s[24:27], s57 offen lds
    s_mov_b32 s10, 512
    s_mov_b32 s11, 0x20000
    v_and_b32 v11, 15, v0
    v_lshrrev_b32 v12, 4, v0
    s_lshl_b32 s56, s50, 5
    s_add_u32 s56, s56, s51
    v_lshl_add_u32 v13, v11, 1, s56
    buffer_load_ushort v244, v13, s[8:11], 0 offen
    s_mul_i32 s56, s52, 7993
    s_add_u32 s56, s56, s55
    s_lshl_b32 s56, s56, 9
    s_add_u32 s28, s14, s56
    s_addc_u32 s29, s15, 0
    s_sub_u32 s30, 7993, s55
    s_min_u32 s30, s30, 250
    s_lshl_b32 s30, s30, 9
    s_mov_b32 s31, 0x20000
    s_mov_b32 s32, s18
    s_mov_b32 s33, s19
    s_mov_b32 s34, 0x200000
    s_mov_b32 s35, 0x20000
    s_mov_b32 s36, s16
    s_mov_b32 s37, s17
    s_mov_b32 s38, 256
    s_mov_b32 s39, 0x20000
    s_lshl_b32 s48, s52, 2
    s_add_u32 s48, s48, s54
    s_lshl_b32 s48, s48, 14
    s_lshl_b32 s49, s53, 9
    s_add_u32 s49, s49, s48
    s_mov_b32 s60, 0x35221100
    s_mov_b32 s61, 0x77625744
    v_add_u32 v13, 0, v11
    v_and_b32 v14, 15, v13
    v_lshlrev_b32 v14, 2, v14
    v_lshrrev_b64 v[14:15], v14, s[60:61]
    v_and_b32 v14, 7, v14
    v_xor_b32 v14, v14, v12
    v_lshlrev_b32 v14, 4, v14
    v_lshl_add_u32 v1, v13, 7, v14
    v_xor_b32 v3, 64, v1
    v_add_u32 v5, 65792, v1
    v_add_u32 v7, 65792, v3
    v_add_u32 v13, 1, v11
    v_and_b32 v14, 15, v13
    v_lshlrev_b32 v14, 2, v14
    v_lshrrev_b64 v[14:15], v14, s[60:61]
    v_and_b32 v14, 7, v14
    v_xor_b32 v14, v14, v12
    v_lshlrev_b32 v14, 4, v14
    v_lshl_add_u32 v2, v13, 7, v14
    v_xor_b32 v4, 64, v2
    v_add_u32 v6, 65792, v2
    v_add_u32 v8, 65792, v4
    v_lshrrev_b32 v13, 2, v11
    v_lshl_add_u32 v14, v12, 3, v13
    v_lshrrev_b32 v13, 1, v13
    v_and_b32 v15, 1, v12
    v_lshl_or_b32 v13, v15, 1, v13
    v_lshlrev_b32 v13, 1, v13
    v_bfe_u32 v15, v0, 1, 1
    s_lshl_b32 s56, s50, 1
    v_or_b32 v15, s56, v15
    v_xor_b32 v13, v13, v15
    v_lshlrev_b32 v13, 4, v13
    v_lshl_add_u32 v9, v14, 7, v13
    v_and_b32 v15, 1, v0
    v_lshl_add_u32 v9, v15, 3, v9
    v_add_u32 v9, 82560, v9
    s_mov_b32 s62, 4294934400
    v_mov_b32 v16, 0
    v_mov_b32 v17, 0
    v_mov_b32 v18, 0
    v_mov_b32 v19, 0
    v_mov_b32 v20, 0
    v_mov_b32 v21, 0
    v_mov_b32 v22, 0
    v_mov_b32 v23, 0
    v_mov_b32 v24, 0
    v_mov_b32 v25, 0
    v_mov_b32 v26, 0
    v_mov_b32 v27, 0
    v_mov_b32 v28, 0
    v_mov_b32 v29, 0
    v_mov_b32 v30, 0
    v_mov_b32 v31, 0
    v_mov_b32 v32, 0
    v_mov_b32 v33, 0
    v_mov_b32 v34, 0
    v_mov_b32 v35, 0
    v_mov_b32 v36, 0
    v_mov_b32 v37, 0
    v_mov_b32 v38, 0
    v_mov_b32 v39, 0
    v_mov_b32 v40, 0
    v_mov_b32 v41, 0
    v_mov_b32 v42, 0
    v_mov_b32 v43, 0
    v_mov_b32 v44, 0
    v_mov_b32 v45, 0
    v_mov_b32 v46, 0
    v_mov_b32 v47, 0
    v_mov_b32 v80, 0
    v_mov_b32 v81, 0
    v_mov_b32 v82, 0
    v_mov_b32 v83, 0
    v_mov_b32 v84, 0
    v_mov_b32 v85, 0
    v_mov_b32 v86, 0
    v_mov_b32 v87, 0
    v_mov_b32 v88, 0
    v_mov_b32 v89, 0
    v_mov_b32 v90, 0
    v_mov_b32 v91, 0
    v_mov_b32 v92, 0
    v_mov_b32 v93, 0
    v_mov_b32 v94, 0
    v_mov_b32 v95, 0
    v_mov_b32 v96, 0
    v_mov_b32 v97, 0
    v_mov_b32 v98, 0
    v_mov_b32 v99, 0
    v_mov_b32 v100, 0
    v_mov_b32 v101, 0
    v_mov_b32 v102, 0
    v_mov_b32 v103, 0
    v_mov_b32 v104, 0
    v_mov_b32 v105, 0
    v_mov_b32 v106, 0
    v_mov_b32 v107, 0
    v_mov_b32 v108, 0
    v_mov_b32 v109, 0
    v_mov_b32 v110, 0
    v_mov_b32 v111, 0
    s_add_u32 s56, s47, 4
    s_and_b32 s56, s56, 7
    s_lshl_b32 s57, s56, 12
    s_add_u32 s57, s57, s59
    s_add_u32 m0, s57, 0
    s_lshl_b32 s57, s56, 18
    s_add_u32 s57, s57, 0
    buffer_load_dwordx4 v10, s[24:27], s57 offen lds
    s_add_u32 s56, s47, 5
    s_and_b32 s56, s56, 7
    s_lshl_b32 s57, s56, 12
    s_add_u32 s57, s57, s59
    s_add_u32 m0, s57, 0
    s_lshl_b32 s57, s56, 18
    s_add_u32 s57, s57, 0
    buffer_load_dwordx4 v10, s[24:27], s57 offen lds
    s_add_u32 s56, s47, 6
    s_and_b32 s56, s56, 7
    s_lshl_b32 s57, s56, 12
    s_add_u32 s57, s57, s59
    s_add_u32 m0, s57, 0
    s_lshl_b32 s57, s56, 18
    s_add_u32 s57, s57, 0
    buffer_load_dwordx4 v10, s[24:27], s57 offen lds
    s_add_u32 s56, s47, 7
    s_and_b32 s56, s56, 7
    s_lshl_b32 s57, s56, 12
    s_add_u32 s57, s57, s59
    s_add_u32 m0, s57, 0
    s_lshl_b32 s57, s56, 18
    s_add_u32 s57, s57, 0
    buffer_load_dwordx4 v10, s[24:27], s57 offen lds
    s_barrier
    s_add_u32 s56, s47, 1
    s_and_b32 s56, s56, 7
    s_lshl_b32 s57, s56, 12
    s_add_u32 s57, s57, s59
    s_add_u32 m0, s57, 32768
    s_lshl_b32 s57, s56, 18
    s_add_u32 s57, s57, 16384
    buffer_load_dwordx4 v10, s[24:27], s57 offen lds
    s_add_u32 s56, s47, 2
    s_and_b32 s56, s56, 7
    s_lshl_b32 s57, s56, 12
    s_add_u32 s57, s57, s59
    s_add_u32 m0, s57, 32768
    s_lshl_b32 s57, s56, 18
    s_add_u32 s57, s57, 16384
    buffer_load_dwordx4 v10, s[24:27], s57 offen lds
    s_add_u32 s56, s47, 3
    s_and_b32 s56, s56, 7
    s_lshl_b32 s57, s56, 12
    s_add_u32 s57, s57, s59
    s_add_u32 m0, s57, 32768
    s_lshl_b32 s57, s56, 18
    s_add_u32 s57, s57, 16384
    buffer_load_dwordx4 v10, s[24:27], s57 offen lds
    s_add_u32 s56, s47, 4
    s_and_b32 s56, s56, 7
    s_lshl_b32 s57, s56, 12
    s_add_u32 s57, s57, s59
    s_add_u32 m0, s57, 32768
    s_lshl_b32 s57, s56, 18
    s_add_u32 s57, s57, 16384
    buffer_load_dwordx4 v10, s[24:27], s57 offen lds
    s_add_u32 s56, s47, 5
    s_and_b32 s56, s56, 7
    s_lshl_b32 s57, s56, 12
    s_add_u32 s57, s57, s59
    s_add_u32 m0, s57, 32768
    s_lshl_b32 s57, s56, 18
    s_add_u32 s57, s57, 16384
    buffer_load_dwordx4 v10, s[24:27], s57 offen lds
    s_add_u32 s56, s47, 6
    s_and_b32 s56, s56, 7
    s_lshl_b32 s57, s56, 12
    s_add_u32 s57, s57, s59
    s_add_u32 m0, s57, 32768
    s_lshl_b32 s57, s56, 18
    s_add_u32 s57, s57, 16384
    buffer_load_dwordx4 v10, s[24:27], s57 offen lds
    s_add_u32 s56, s47, 7
    s_and_b32 s56, s56, 7
    s_lshl_b32 s57, s56, 12
    s_add_u32 s57, s57, s59
    s_add_u32 m0, s57, 32768
    s_lshl_b32 s57, s56, 18
    s_add_u32 s57, s57, 16384
    buffer_load_dwordx4 v10, s[24:27], s57 offen lds
    s_waitcnt vmcnt(11)
    v_add_u32 v10, 16, v0
    v_and_b32 v10, 63, v10
    v_lshlrev_b32 v10, 2, v10
    s_lshl_b32 s56, s50, 7
    s_add_u32 s56, s56, s49
    v_lshl_add_u32 v13, v0, 3, s56
    v_lshlrev_b32 v244, 16, v244
    v_mov_b32 v48, v244
    v_mov_b32 v49, v244
    v_mov_b32 v50, v244
    v_mov_b32 v51, v244
    v_mov_b32 v52, v244
    v_mov_b32 v53, v244
    v_mov_b32 v54, v244
    v_mov_b32 v55, v244
    v_mov_b32 v56, v244
    v_mov_b32 v57, v244
    v_mov_b32 v58, v244
    v_mov_b32 v59, v244
    v_mov_b32 v60, v244
    v_mov_b32 v61, v244
    v_mov_b32 v62, v244
    v_mov_b32 v63, v244
    v_mov_b32 v64, v244
    v_mov_b32 v65, v244
    v_mov_b32 v66, v244
    v_mov_b32 v67, v244
    v_mov_b32 v68, v244
    v_mov_b32 v69, v244
    v_mov_b32 v70, v244
    v_mov_b32 v71, v244
    v_mov_b32 v72, v244
    v_mov_b32 v73, v244
    v_mov_b32 v74, v244
    v_mov_b32 v75, v244
    v_mov_b32 v76, v244
    v_mov_b32 v77, v244
    v_mov_b32 v78, v244
    v_mov_b32 v79, v244
    s_waitcnt vmcnt(7)
    s_barrier
    ds_read_b64_tr_b16 v[180:181], v9 offset:0
    ds_read_b64_tr_b16 v[182:183], v9 offset:512
    ds_read_b64_tr_b16 v[196:197], v9 offset:4096
    ds_read_b64_tr_b16 v[198:199], v9 offset:4608
    ds_read_b128 v[112:115], v1 offset:0
    ds_read_b64_tr_b16 v[184:185], v9 offset:8192
    ds_read_b64_tr_b16 v[200:201], v9 offset:12288
    ds_read_b64_tr_b16 v[186:187], v9 offset:8704
    ds_read_b64_tr_b16 v[202:203], v9 offset:12800
    ds_read_b128 v[116:119], v1 offset:2176
    ds_read_b64_tr_b16 v[188:189], v9 offset:16384
    ds_read_b64_tr_b16 v[190:191], v9 offset:16896
    ds_read_b128 v[120:123], v1 offset:4224
    ds_read_b64_tr_b16 v[192:193], v9 offset:24576
    ds_read_b64_tr_b16 v[194:195], v9 offset:25088
    ds_read_b128 v[124:127], v1 offset:6272
    ds_read_b128 v[128:131], v1 offset:8320
    ds_read_b128 v[132:135], v1 offset:10368
    s_waitcnt lgkmcnt(15)
    v_lshlrev_b32 v244, 16, v180
    v_lshlrev_b32 v246, 16, v196
    v_and_b32 v245, s58, v180
    v_and_b32 v247, s58, v196
    v_sub_f32 v244, v244, v246
    v_sub_f32 v245, v245, v247
    v_lshlrev_b32 v248, 16, v181
    v_cvt_pk_bf16_f32 v212, v244, v245
    v_lshlrev_b32 v250, 16, v197
    v_and_b32 v249, s58, v181
    v_and_b32 v251, s58, v197
    v_sub_f32 v248, v248, v250
    v_sub_f32 v249, v249, v251
    v_lshlrev_b32 v244, 16, v182
    v_cvt_pk_bf16_f32 v213, v248, v249
    s_waitcnt lgkmcnt(14)
    v_lshlrev_b32 v246, 16, v198
    v_and_b32 v245, s58, v182
    v_and_b32 v247, s58, v198
    v_sub_f32 v244, v244, v246
    v_sub_f32 v245, v245, v247
    v_cvt_pk_bf16_f32 v214, v244, v245
    s_waitcnt lgkmcnt(0)
    s_nop 0
    s_mov_b32 s64, 4
.p2align 3
L_body0:
    v_mfma_f32_16x16x32_bf16 v[16:19], v[112:115], v[180:183], v[16:19]
    ds_read_b128 v[136:139], v1 offset:12416
    v_lshlrev_b32 v248, 16, v183
    v_mfma_f32_16x16x32_bf16 v[16:19], v[116:119], v[184:187], v[16:19]
    ds_read_b128 v[140:143], v1 offset:14464
    v_lshlrev_b32 v250, 16, v199
    s_waitcnt lgkmcnt(2)
    v_mfma_f32_16x16x32_bf16 v[16:19], v[120:123], v[188:191], v[16:19]
    ds_read_b64_tr_b16 v[204:205], v9 offset:20480
    v_and_b32 v249, s58, v183
    v_mfma_f32_16x16x32_bf16 v[16:19], v[124:127], v[192:195], v[16:19]
    ds_read_b64_tr_b16 v[206:207], v9 offset:20992
    v_and_b32 v251, s58, v199
    v_mfma_f32_16x16x32_bf16 v[20:23], v[116:119], v[180:183], v[20:23]
    ds_read_b64_tr_b16 v[208:209], v9 offset:28672
    v_sub_f32 v248, v248, v250
    v_mfma_f32_16x16x32_bf16 v[20:23], v[120:123], v[184:187], v[20:23]
    ds_read_b64_tr_b16 v[210:211], v9 offset:29184
    v_sub_f32 v249, v249, v251
    v_mfma_f32_16x16x32_bf16 v[20:23], v[124:127], v[188:191], v[20:23]
    ds_read_b128 v[144:147], v2 offset:0
    v_lshlrev_b32 v244, 16, v184
    v_mfma_f32_16x16x32_bf16 v[20:23], v[128:131], v[192:195], v[20:23]
    ds_read_b128 v[148:151], v2 offset:2176
    v_cvt_pk_bf16_f32 v215, v248, v249
    v_mfma_f32_16x16x32_bf16 v[24:27], v[120:123], v[180:183], v[24:27]
    ds_read_b128 v[112:115], v1 offset:16512
    v_lshlrev_b32 v246, 16, v200
    v_mfma_f32_16x16x32_bf16 v[24:27], v[124:127], v[184:187], v[24:27]
    ds_read_b128 v[116:119], v1 offset:18560
    v_and_b32 v245, s58, v184
    v_mfma_f32_16x16x32_bf16 v[24:27], v[128:131], v[188:191], v[24:27]
    ds_read_b128 v[120:123], v1 offset:20608
    v_and_b32 v247, s58, v200
    v_mfma_f32_16x16x32_bf16 v[24:27], v[132:135], v[192:195], v[24:27]
    ds_read_b128 v[156:159], v1 offset:26752
    v_sub_f32 v244, v244, v246
    v_mfma_f32_16x16x32_bf16 v[28:31], v[124:127], v[180:183], v[28:31]
    ds_read_b128 v[124:127], v1 offset:22656
    v_sub_f32 v245, v245, v247
    v_mfma_f32_16x16x32_bf16 v[28:31], v[128:131], v[184:187], v[28:31]
    ds_read_b128 v[160:163], v1 offset:28800
    v_lshlrev_b32 v248, 16, v185
    v_mfma_f32_16x16x32_bf16 v[28:31], v[132:135], v[188:191], v[28:31]
    ds_read_b128 v[164:167], v1 offset:30848
    v_cvt_pk_bf16_f32 v216, v244, v245
    s_waitcnt lgkmcnt(11)
    v_mfma_f32_16x16x32_bf16 v[28:31], v[136:139], v[192:195], v[28:31]
    ds_read_b128 v[168:171], v2 offset:16512
    v_lshlrev_b32 v250, 16, v201
    v_mfma_f32_16x16x32_bf16 v[32:35], v[128:131], v[180:183], v[32:35]
    ds_read_b128 v[128:131], v1 offset:24704
    v_and_b32 v249, s58, v185
    v_mfma_f32_16x16x32_bf16 v[32:35], v[132:135], v[184:187], v[32:35]
    ds_read_b128 v[172:175], v2 offset:18560
    v_and_b32 v251, s58, v201
    v_mfma_f32_16x16x32_bf16 v[32:35], v[136:139], v[188:191], v[32:35]
    ds_read_b128 v[176:179], v2 offset:20608
    v_sub_f32 v248, v248, v250
    v_mfma_f32_16x16x32_bf16 v[32:35], v[140:143], v[192:195], v[32:35]
    ds_read_b128 v[152:155], v2 offset:4224
    v_sub_f32 v249, v249, v251
    v_mfma_f32_16x16x32_bf16 v[36:39], v[132:135], v[180:183], v[36:39]
    s_waitcnt lgkmcnt(11)
    s_barrier
    v_lshlrev_b32 v244, 16, v186
    v_mfma_f32_16x16x32_bf16 v[36:39], v[136:139], v[184:187], v[36:39]
    v_cvt_pk_bf16_f32 v217, v248, v249
    v_lshlrev_b32 v246, 16, v202
    v_mfma_f32_16x16x32_bf16 v[36:39], v[140:143], v[188:191], v[36:39]
    v_and_b32 v245, s58, v186
    v_and_b32 v247, s58, v202
    v_mfma_f32_16x16x32_bf16 v[36:39], v[144:147], v[192:195], v[36:39]
    v_sub_f32 v244, v244, v246
    v_sub_f32 v245, v245, v247
    v_mfma_f32_16x16x32_bf16 v[40:43], v[136:139], v[180:183], v[40:43]
    v_lshlrev_b32 v248, 16, v187
    v_cvt_pk_bf16_f32 v218, v244, v245
    v_mfma_f32_16x16x32_bf16 v[40:43], v[140:143], v[184:187], v[40:43]
    v_lshlrev_b32 v250, 16, v203
    v_and_b32 v249, s58, v187
    v_mfma_f32_16x16x32_bf16 v[40:43], v[144:147], v[188:191], v[40:43]
    v_and_b32 v251, s58, v203
    v_sub_f32 v248, v248, v250
    v_mfma_f32_16x16x32_bf16 v[40:43], v[148:151], v[192:195], v[40:43]
    v_sub_f32 v249, v249, v251
    v_lshlrev_b32 v244, 16, v188
    v_mfma_f32_16x16x32_bf16 v[44:47], v[140:143], v[180:183], v[44:47]
    v_cvt_pk_bf16_f32 v219, v248, v249
    v_lshlrev_b32 v246, 16, v204
    v_mfma_f32_16x16x32_bf16 v[44:47], v[144:147], v[184:187], v[44:47]
    v_and_b32 v245, s58, v188
    v_and_b32 v247, s58, v204
    v_mfma_f32_16x16x32_bf16 v[44:47], v[148:151], v[188:191], v[44:47]
    v_sub_f32 v244, v244, v246
    v_sub_f32 v245, v245, v247
    s_waitcnt lgkmcnt(0)
    v_mfma_f32_16x16x32_bf16 v[44:47], v[152:155], v[192:195], v[44:47]
    v_lshlrev_b32 v248, 16, v189
    v_cvt_pk_bf16_f32 v220, v244, v245
    v_mfma_f32_16x16x32_bf16 v[48:51], v[112:115], v[196:199], v[48:51]
    v_lshlrev_b32 v250, 16, v205
    v_and_b32 v249, s58, v189
    v_mfma_f32_16x16x32_bf16 v[48:51], v[116:119], v[200:203], v[48:51]
    v_and_b32 v251, s58, v205
    v_sub_f32 v248, v248, v250
    v_mfma_f32_16x16x32_bf16 v[48:51], v[120:123], v[204:207], v[48:51]
    v_sub_f32 v249, v249, v251
    v_lshlrev_b32 v244, 16, v190
    v_mfma_f32_16x16x32_bf16 v[48:51], v[124:127], v[208:211], v[48:51]
    v_cvt_pk_bf16_f32 v221, v248, v249
    v_lshlrev_b32 v246, 16, v206
    v_mfma_f32_16x16x32_bf16 v[52:55], v[116:119], v[196:199], v[52:55]
    v_and_b32 v245, s58, v190
    v_and_b32 v247, s58, v206
    v_mfma_f32_16x16x32_bf16 v[52:55], v[120:123], v[200:203], v[52:55]
    v_sub_f32 v244, v244, v246
    v_sub_f32 v245, v245, v247
    v_mfma_f32_16x16x32_bf16 v[52:55], v[124:127], v[204:207], v[52:55]
    v_lshlrev_b32 v248, 16, v191
    v_cvt_pk_bf16_f32 v222, v244, v245
    v_mfma_f32_16x16x32_bf16 v[52:55], v[128:131], v[208:211], v[52:55]
    v_lshlrev_b32 v250, 16, v207
    v_and_b32 v249, s58, v191
    v_mfma_f32_16x16x32_bf16 v[56:59], v[120:123], v[196:199], v[56:59]
    v_and_b32 v251, s58, v207
    v_sub_f32 v248, v248, v250
    v_mfma_f32_16x16x32_bf16 v[56:59], v[124:127], v[200:203], v[56:59]
    v_sub_f32 v249, v249, v251
    v_lshlrev_b32 v244, 16, v192
    v_mfma_f32_16x16x32_bf16 v[56:59], v[128:131], v[204:207], v[56:59]
    v_cvt_pk_bf16_f32 v223, v248, v249
    v_lshlrev_b32 v246, 16, v208
    v_mfma_f32_16x16x32_bf16 v[56:59], v[156:159], v[208:211], v[56:59]
    v_and_b32 v245, s58, v192
    v_and_b32 v247, s58, v208
    v_mfma_f32_16x16x32_bf16 v[60:63], v[124:127], v[196:199], v[60:63]
    v_sub_f32 v244, v244, v246
    v_sub_f32 v245, v245, v247
    v_mfma_f32_16x16x32_bf16 v[60:63], v[128:131], v[200:203], v[60:63]
    v_lshlrev_b32 v248, 16, v193
    v_mfma_f32_16x16x32_bf16 v[60:63], v[156:159], v[204:207], v[60:63]
    s_barrier
    ds_read_b128 v[112:115], v5 offset:0
    v_mfma_f32_16x16x32_bf16 v[60:63], v[160:163], v[208:211], v[60:63]
    ds_read_b128 v[116:119], v5 offset:2048
    v_cvt_pk_bf16_f32 v224, v244, v245
    v_mfma_f32_16x16x32_bf16 v[64:67], v[128:131], v[196:199], v[64:67]
    ds_read_b128 v[120:123], v5 offset:4096
    v_lshlrev_b32 v250, 16, v209
    v_mfma_f32_16x16x32_bf16 v[64:67], v[156:159], v[200:203], v[64:67]
    ds_read_b128 v[124:127], v5 offset:6144
    v_and_b32 v249, s58, v193
    v_mfma_f32_16x16x32_bf16 v[64:67], v[160:163], v[204:207], v[64:67]
    ds_read_b128 v[128:131], v5 offset:8192
    v_and_b32 v251, s58, v209
    v_mfma_f32_16x16x32_bf16 v[64:67], v[164:167], v[208:211], v[64:67]
    ds_read_b128 v[132:135], v5 offset:10240
    v_sub_f32 v248, v248, v250
    v_mfma_f32_16x16x32_bf16 v[68:71], v[156:159], v[196:199], v[68:71]
    v_sub_f32 v249, v249, v251
    v_lshlrev_b32 v244, 16, v194
    v_mfma_f32_16x16x32_bf16 v[68:71], v[160:163], v[200:203], v[68:71]
    v_cvt_pk_bf16_f32 v225, v248, v249
    v_lshlrev_b32 v246, 16, v210
    v_mfma_f32_16x16x32_bf16 v[68:71], v[164:167], v[204:207], v[68:71]
    v_and_b32 v245, s58, v194
    v_and_b32 v247, s58, v210
    v_mfma_f32_16x16x32_bf16 v[68:71], v[168:171], v[208:211], v[68:71]
    ds_read_b128 v[136:139], v5 offset:12288
    v_sub_f32 v244, v244, v246
    v_mfma_f32_16x16x32_bf16 v[72:75], v[160:163], v[196:199], v[72:75]
    v_sub_f32 v245, v245, v247
    v_lshlrev_b32 v248, 16, v195
    v_mfma_f32_16x16x32_bf16 v[72:75], v[164:167], v[200:203], v[72:75]
    v_cvt_pk_bf16_f32 v226, v244, v245
    v_lshlrev_b32 v250, 16, v211
    v_mfma_f32_16x16x32_bf16 v[72:75], v[168:171], v[204:207], v[72:75]
    v_and_b32 v249, s58, v195
    v_and_b32 v251, s58, v211
    v_mfma_f32_16x16x32_bf16 v[72:75], v[172:175], v[208:211], v[72:75]
    ds_read_b128 v[140:143], v5 offset:14336
    v_sub_f32 v248, v248, v250
    v_mfma_f32_16x16x32_bf16 v[76:79], v[164:167], v[196:199], v[76:79]
    v_sub_f32 v249, v249, v251
    v_cvt_pk_bf16_f32 v227, v248, v249
    v_mfma_f32_16x16x32_bf16 v[76:79], v[168:171], v[200:203], v[76:79]
    v_mfma_f32_16x16x32_bf16 v[76:79], v[172:175], v[204:207], v[76:79]
    v_mfma_f32_16x16x32_bf16 v[76:79], v[176:179], v[208:211], v[76:79]
    ds_read_b128 v[144:147], v6 offset:0
    s_waitcnt lgkmcnt(3)
    v_mfma_f32_16x16x32_bf16 v[80:83], v[112:115], v[212:215], v[80:83]
    v_mfma_f32_16x16x32_bf16 v[80:83], v[116:119], v[216:219], v[80:83]
    s_waitcnt vmcnt(0)
    s_barrier
    ds_read_b64_tr_b16 v[180:181], v9 offset:32768
    v_mfma_f32_16x16x32_bf16 v[80:83], v[120:123], v[220:223], v[80:83]
    ds_read_b64_tr_b16 v[182:183], v9 offset:33280
    v_mfma_f32_16x16x32_bf16 v[80:83], v[124:127], v[224:227], v[80:83]
    ds_read_b64_tr_b16 v[196:197], v9 offset:36864
    v_mfma_f32_16x16x32_bf16 v[84:87], v[116:119], v[212:215], v[84:87]
    ds_read_b64_tr_b16 v[198:199], v9 offset:37376
    v_mfma_f32_16x16x32_bf16 v[84:87], v[120:123], v[216:219], v[84:87]
    ds_read_b128 v[148:151], v6 offset:2048
    v_mfma_f32_16x16x32_bf16 v[84:87], v[124:127], v[220:223], v[84:87]
    v_mfma_f32_16x16x32_bf16 v[84:87], v[128:131], v[224:227], v[84:87]
    ds_read_b128 v[152:155], v6 offset:4096
    v_mfma_f32_16x16x32_bf16 v[88:91], v[120:123], v[212:215], v[88:91]
    ds_read_b128 v[112:115], v3 offset:0
    v_mfma_f32_16x16x32_bf16 v[88:91], v[124:127], v[216:219], v[88:91]
    ds_read_b64_tr_b16 v[184:185], v9 offset:40960
    v_mfma_f32_16x16x32_bf16 v[88:91], v[128:131], v[220:223], v[88:91]
    ds_read_b64_tr_b16 v[200:201], v9 offset:45056
    v_mfma_f32_16x16x32_bf16 v[88:91], v[132:135], v[224:227], v[88:91]
    ds_read_b64_tr_b16 v[186:187], v9 offset:41472
    v_mfma_f32_16x16x32_bf16 v[92:95], v[124:127], v[212:215], v[92:95]
    ds_read_b64_tr_b16 v[202:203], v9 offset:45568
    v_mfma_f32_16x16x32_bf16 v[92:95], v[128:131], v[216:219], v[92:95]
    ds_read_b128 v[116:119], v3 offset:2176
    s_waitcnt lgkmcnt(11)
    v_lshlrev_b32 v244, 16, v180
    v_mfma_f32_16x16x32_bf16 v[92:95], v[132:135], v[220:223], v[92:95]
    ds_read_b64_tr_b16 v[188:189], v9 offset:49152
    s_waitcnt lgkmcnt(10)
    v_lshlrev_b32 v246, 16, v196
    v_mfma_f32_16x16x32_bf16 v[92:95], v[136:139], v[224:227], v[92:95]
    ds_read_b64_tr_b16 v[190:191], v9 offset:49664
    v_and_b32 v245, s58, v180
    v_mfma_f32_16x16x32_bf16 v[96:99], v[128:131], v[212:215], v[96:99]
    ds_read_b128 v[120:123], v3 offset:4224
    v_and_b32 v247, s58, v196
    v_mfma_f32_16x16x32_bf16 v[96:99], v[132:135], v[216:219], v[96:99]
    ds_read_b64_tr_b16 v[192:193], v9 offset:57344
    v_sub_f32 v244, v244, v246
    v_mfma_f32_16x16x32_bf16 v[96:99], v[136:139], v[220:223], v[96:99]
    ds_read_b64_tr_b16 v[194:195], v9 offset:57856
    v_sub_f32 v245, v245, v247
    v_mfma_f32_16x16x32_bf16 v[96:99], v[140:143], v[224:227], v[96:99]
    ds_read_b128 v[124:127], v3 offset:6272
    v_lshlrev_b32 v248, 16, v181
    v_mfma_f32_16x16x32_bf16 v[100:103], v[132:135], v[212:215], v[100:103]
    ds_read_b128 v[128:131], v3 offset:8320
    v_cvt_pk_bf16_f32 v228, v244, v245
    v_mfma_f32_16x16x32_bf16 v[100:103], v[136:139], v[216:219], v[100:103]
    ds_read_b128 v[132:135], v3 offset:10368
    v_lshlrev_b32 v250, 16, v197
    v_mfma_f32_16x16x32_bf16 v[100:103], v[140:143], v[220:223], v[100:103]
    v_and_b32 v249, s58, v181
    v_and_b32 v251, s58, v197
    v_mfma_f32_16x16x32_bf16 v[100:103], v[144:147], v[224:227], v[100:103]
    v_sub_f32 v248, v248, v250
    v_sub_f32 v249, v249, v251
    v_mfma_f32_16x16x32_bf16 v[104:107], v[136:139], v[212:215], v[104:107]
    v_lshlrev_b32 v244, 16, v182
    v_cvt_pk_bf16_f32 v229, v248, v249
    v_mfma_f32_16x16x32_bf16 v[104:107], v[140:143], v[216:219], v[104:107]
    s_waitcnt lgkmcnt(8)
    v_lshlrev_b32 v246, 16, v198
    v_and_b32 v245, s58, v182
    v_mfma_f32_16x16x32_bf16 v[104:107], v[144:147], v[220:223], v[104:107]
    v_and_b32 v247, s58, v198
    v_mfma_f32_16x16x32_bf16 v[104:107], v[148:151], v[224:227], v[104:107]
    v_sub_f32 v244, v244, v246
    v_mfma_f32_16x16x32_bf16 v[108:111], v[140:143], v[212:215], v[108:111]
    v_sub_f32 v245, v245, v247
    v_mfma_f32_16x16x32_bf16 v[108:111], v[144:147], v[216:219], v[108:111]
    v_cvt_pk_bf16_f32 v230, v244, v245
    v_mfma_f32_16x16x32_bf16 v[108:111], v[148:151], v[220:223], v[108:111]
    v_mfma_f32_16x16x32_bf16 v[108:111], v[152:155], v[224:227], v[108:111]
    v_mfma_f32_16x16x32_bf16 v[16:19], v[112:115], v[180:183], v[16:19]
    ds_read_b128 v[136:139], v3 offset:12416
    v_lshlrev_b32 v248, 16, v183
    v_mfma_f32_16x16x32_bf16 v[16:19], v[116:119], v[184:187], v[16:19]
    ds_read_b128 v[140:143], v3 offset:14464
    v_lshlrev_b32 v250, 16, v199
    s_waitcnt lgkmcnt(2)
    v_mfma_f32_16x16x32_bf16 v[16:19], v[120:123], v[188:191], v[16:19]
    ds_read_b64_tr_b16 v[204:205], v9 offset:53248
    v_and_b32 v249, s58, v183
    v_mfma_f32_16x16x32_bf16 v[16:19], v[124:127], v[192:195], v[16:19]
    ds_read_b64_tr_b16 v[206:207], v9 offset:53760
    v_and_b32 v251, s58, v199
    v_mfma_f32_16x16x32_bf16 v[20:23], v[116:119], v[180:183], v[20:23]
    ds_read_b64_tr_b16 v[208:209], v9 offset:61440
    v_sub_f32 v248, v248, v250
    v_mfma_f32_16x16x32_bf16 v[20:23], v[120:123], v[184:187], v[20:23]
    ds_read_b64_tr_b16 v[210:211], v9 offset:61952
    v_sub_f32 v249, v249, v251
    v_mfma_f32_16x16x32_bf16 v[20:23], v[124:127], v[188:191], v[20:23]
    ds_read_b128 v[144:147], v4 offset:0
    v_lshlrev_b32 v244, 16, v184
    v_mfma_f32_16x16x32_bf16 v[20:23], v[128:131], v[192:195], v[20:23]
    ds_read_b128 v[148:151], v4 offset:2176
    v_cvt_pk_bf16_f32 v231, v248, v249
    v_mfma_f32_16x16x32_bf16 v[24:27], v[120:123], v[180:183], v[24:27]
    ds_read_b128 v[152:155], v4 offset:4224
    v_lshlrev_b32 v246, 16, v200
    v_mfma_f32_16x16x32_bf16 v[24:27], v[124:127], v[184:187], v[24:27]
    ds_read_b128 v[112:115], v3 offset:16512
    v_and_b32 v245, s58, v184
    v_mfma_f32_16x16x32_bf16 v[24:27], v[128:131], v[188:191], v[24:27]
    ds_read_b128 v[116:119], v3 offset:18560
    v_and_b32 v247, s58, v200
    v_mfma_f32_16x16x32_bf16 v[24:27], v[132:135], v[192:195], v[24:27]
    ds_read_b128 v[120:123], v3 offset:20608
    v_sub_f32 v244, v244, v246
    v_mfma_f32_16x16x32_bf16 v[28:31], v[124:127], v[180:183], v[28:31]
    ds_read_b128 v[124:127], v3 offset:22656
    v_sub_f32 v245, v245, v247
    v_mfma_f32_16x16x32_bf16 v[28:31], v[128:131], v[184:187], v[28:31]
    v_lshlrev_b32 v248, 16, v185
    v_cvt_pk_bf16_f32 v232, v244, v245
    v_mfma_f32_16x16x32_bf16 v[28:31], v[132:135], v[188:191], v[28:31]
    v_lshlrev_b32 v250, 16, v201
    v_and_b32 v249, s58, v185
    s_waitcnt lgkmcnt(9)
    v_mfma_f32_16x16x32_bf16 v[28:31], v[136:139], v[192:195], v[28:31]
    v_and_b32 v251, s58, v201
    v_sub_f32 v248, v248, v250
    v_mfma_f32_16x16x32_bf16 v[32:35], v[128:131], v[180:183], v[32:35]
    ds_read_b128 v[128:131], v3 offset:24704
    v_sub_f32 v249, v249, v251
    v_mfma_f32_16x16x32_bf16 v[32:35], v[132:135], v[184:187], v[32:35]
    v_lshlrev_b32 v244, 16, v186
    v_cvt_pk_bf16_f32 v233, v248, v249
    v_mfma_f32_16x16x32_bf16 v[32:35], v[136:139], v[188:191], v[32:35]
    v_lshlrev_b32 v246, 16, v202
    v_and_b32 v245, s58, v186
    v_mfma_f32_16x16x32_bf16 v[32:35], v[140:143], v[192:195], v[32:35]
    ds_read_b128 v[156:159], v3 offset:26752
    v_and_b32 v247, s58, v202
    v_mfma_f32_16x16x32_bf16 v[36:39], v[132:135], v[180:183], v[36:39]
    s_waitcnt lgkmcnt(6)
    s_barrier
    v_sub_f32 v244, v244, v246
    v_mfma_f32_16x16x32_bf16 v[36:39], v[136:139], v[184:187], v[36:39]
    v_sub_f32 v245, v245, v247
    v_lshlrev_b32 v248, 16, v187
    v_mfma_f32_16x16x32_bf16 v[36:39], v[140:143], v[188:191], v[36:39]
    v_cvt_pk_bf16_f32 v234, v244, v245
    v_lshlrev_b32 v250, 16, v203
    v_mfma_f32_16x16x32_bf16 v[36:39], v[144:147], v[192:195], v[36:39]
    ds_read_b128 v[160:163], v3 offset:28800
    v_and_b32 v249, s58, v187
    v_mfma_f32_16x16x32_bf16 v[40:43], v[136:139], v[180:183], v[40:43]
    v_and_b32 v251, s58, v203
    v_sub_f32 v248, v248, v250
    v_mfma_f32_16x16x32_bf16 v[40:43], v[140:143], v[184:187], v[40:43]
    v_sub_f32 v249, v249, v251
    v_lshlrev_b32 v244, 16, v188
    v_mfma_f32_16x16x32_bf16 v[40:43], v[144:147], v[188:191], v[40:43]
    v_cvt_pk_bf16_f32 v235, v248, v249
    v_lshlrev_b32 v246, 16, v204
    v_mfma_f32_16x16x32_bf16 v[40:43], v[148:151], v[192:195], v[40:43]
    ds_read_b128 v[164:167], v3 offset:30848
    v_and_b32 v245, s58, v188
    v_mfma_f32_16x16x32_bf16 v[44:47], v[140:143], v[180:183], v[44:47]
    v_and_b32 v247, s58, v204
    v_sub_f32 v244, v244, v246
    v_mfma_f32_16x16x32_bf16 v[44:47], v[144:147], v[184:187], v[44:47]
    v_sub_f32 v245, v245, v247
    v_lshlrev_b32 v248, 16, v189
    v_mfma_f32_16x16x32_bf16 v[44:47], v[148:151], v[188:191], v[44:47]
    v_cvt_pk_bf16_f32 v236, v244, v245
    v_lshlrev_b32 v250, 16, v205
    v_mfma_f32_16x16x32_bf16 v[44:47], v[152:155], v[192:195], v[44:47]
    ds_read_b128 v[168:171], v4 offset:16512
    v_and_b32 v249, s58, v189
    s_waitcnt lgkmcnt(3)
    v_mfma_f32_16x16x32_bf16 v[48:51], v[112:115], v[196:199], v[48:51]
    v_and_b32 v251, s58, v205
    v_sub_f32 v248, v248, v250
    v_mfma_f32_16x16x32_bf16 v[48:51], v[116:119], v[200:203], v[48:51]
    v_sub_f32 v249, v249, v251
    v_lshlrev_b32 v244, 16, v190
    v_mfma_f32_16x16x32_bf16 v[48:51], v[120:123], v[204:207], v[48:51]
    v_cvt_pk_bf16_f32 v237, v248, v249
    v_lshlrev_b32 v246, 16, v206
    v_mfma_f32_16x16x32_bf16 v[48:51], v[124:127], v[208:211], v[48:51]
    ds_read_b128 v[172:175], v4 offset:18560
    v_and_b32 v245, s58, v190
    v_mfma_f32_16x16x32_bf16 v[52:55], v[116:119], v[196:199], v[52:55]
    v_and_b32 v247, s58, v206
    v_sub_f32 v244, v244, v246
    v_mfma_f32_16x16x32_bf16 v[52:55], v[120:123], v[200:203], v[52:55]
    v_sub_f32 v245, v245, v247
    v_lshlrev_b32 v248, 16, v191
    v_mfma_f32_16x16x32_bf16 v[52:55], v[124:127], v[204:207], v[52:55]
    v_cvt_pk_bf16_f32 v238, v244, v245
    v_lshlrev_b32 v250, 16, v207
    v_mfma_f32_16x16x32_bf16 v[52:55], v[128:131], v[208:211], v[52:55]
    ds_read_b128 v[176:179], v4 offset:20608
    v_and_b32 v249, s58, v191
    v_mfma_f32_16x16x32_bf16 v[56:59], v[120:123], v[196:199], v[56:59]
    ds_read_b128 v[112:115], v7 offset:0
    v_and_b32 v251, s58, v207
    v_mfma_f32_16x16x32_bf16 v[56:59], v[124:127], v[200:203], v[56:59]
    ds_read_b128 v[116:119], v7 offset:2048
    v_sub_f32 v248, v248, v250
    v_mfma_f32_16x16x32_bf16 v[56:59], v[128:131], v[204:207], v[56:59]
    ds_read_b128 v[120:123], v7 offset:4096
    v_sub_f32 v249, v249, v251
    v_mfma_f32_16x16x32_bf16 v[56:59], v[156:159], v[208:211], v[56:59]
    v_lshlrev_b32 v244, 16, v192
    v_cvt_pk_bf16_f32 v239, v248, v249
    v_mfma_f32_16x16x32_bf16 v[60:63], v[124:127], v[196:199], v[60:63]
    ds_read_b128 v[124:127], v7 offset:6144
    v_lshlrev_b32 v246, 16, v208
    v_mfma_f32_16x16x32_bf16 v[60:63], v[128:131], v[200:203], v[60:63]
    v_and_b32 v245, s58, v192
    v_and_b32 v247, s58, v208
    v_mfma_f32_16x16x32_bf16 v[60:63], v[156:159], v[204:207], v[60:63]
    v_sub_f32 v244, v244, v246
    v_sub_f32 v245, v245, v247
    s_waitcnt lgkmcnt(5)
    v_mfma_f32_16x16x32_bf16 v[60:63], v[160:163], v[208:211], v[60:63]
    v_lshlrev_b32 v248, 16, v193
    v_cvt_pk_bf16_f32 v240, v244, v245
    v_mfma_f32_16x16x32_bf16 v[64:67], v[128:131], v[196:199], v[64:67]
    ds_read_b128 v[128:131], v7 offset:8192
    v_lshlrev_b32 v250, 16, v209
    v_mfma_f32_16x16x32_bf16 v[64:67], v[156:159], v[200:203], v[64:67]
    v_and_b32 v249, s58, v193
    v_and_b32 v251, s58, v209
    v_mfma_f32_16x16x32_bf16 v[64:67], v[160:163], v[204:207], v[64:67]
    v_sub_f32 v248, v248, v250
    v_sub_f32 v249, v249, v251
    v_mfma_f32_16x16x32_bf16 v[64:67], v[164:167], v[208:211], v[64:67]
    ds_read_b128 v[132:135], v7 offset:10240
    v_lshlrev_b32 v244, 16, v194
    v_mfma_f32_16x16x32_bf16 v[68:71], v[156:159], v[196:199], v[68:71]
    v_cvt_pk_bf16_f32 v241, v248, v249
    v_lshlrev_b32 v246, 16, v210
    v_mfma_f32_16x16x32_bf16 v[68:71], v[160:163], v[200:203], v[68:71]
    v_and_b32 v245, s58, v194
    v_and_b32 v247, s58, v210
    v_mfma_f32_16x16x32_bf16 v[68:71], v[164:167], v[204:207], v[68:71]
    v_sub_f32 v244, v244, v246
    v_sub_f32 v245, v245, v247
    v_mfma_f32_16x16x32_bf16 v[68:71], v[168:171], v[208:211], v[68:71]
    ds_read_b128 v[136:139], v7 offset:12288
    v_lshlrev_b32 v248, 16, v195
    v_mfma_f32_16x16x32_bf16 v[72:75], v[160:163], v[196:199], v[72:75]
    v_cvt_pk_bf16_f32 v242, v244, v245
    s_sub_u32 s62, 0, s62
    v_mfma_f32_16x16x32_bf16 v[72:75], v[164:167], v[200:203], v[72:75]
    v_lshlrev_b32 v250, 16, v211
    v_add_u32 v1, s62, v1
    v_mfma_f32_16x16x32_bf16 v[72:75], v[168:171], v[204:207], v[72:75]
    v_and_b32 v249, s58, v195
    v_and_b32 v251, s58, v211
    v_mfma_f32_16x16x32_bf16 v[72:75], v[172:175], v[208:211], v[72:75]
    ds_read_b128 v[140:143], v7 offset:14336
    v_add_u32 v2, s62, v2
    v_mfma_f32_16x16x32_bf16 v[76:79], v[164:167], v[196:199], v[76:79]
    v_sub_f32 v248, v248, v250
    v_sub_f32 v249, v249, v251
    v_mfma_f32_16x16x32_bf16 v[76:79], v[168:171], v[200:203], v[76:79]
    v_cvt_pk_bf16_f32 v243, v248, v249
    v_add_u32 v3, s62, v3
    v_mfma_f32_16x16x32_bf16 v[76:79], v[172:175], v[204:207], v[76:79]
    s_waitcnt lgkmcnt(2)
    v_mfma_f32_16x16x32_bf16 v[76:79], v[176:179], v[208:211], v[76:79]
    ds_read_b128 v[144:147], v8 offset:0
    v_add_u32 v4, s62, v4
    v_mfma_f32_16x16x32_bf16 v[80:83], v[112:115], v[228:231], v[80:83]
    v_mfma_f32_16x16x32_bf16 v[80:83], v[116:119], v[232:235], v[80:83]
    s_barrier
    ds_read_b64_tr_b16 v[180:181], v9 offset:0
    v_mfma_f32_16x16x32_bf16 v[80:83], v[120:123], v[236:239], v[80:83]
    ds_read_b64_tr_b16 v[182:183], v9 offset:512
    v_mfma_f32_16x16x32_bf16 v[80:83], v[124:127], v[240:243], v[80:83]
    ds_read_b64_tr_b16 v[196:197], v9 offset:4096
    v_mfma_f32_16x16x32_bf16 v[84:87], v[116:119], v[228:231], v[84:87]
    ds_read_b64_tr_b16 v[198:199], v9 offset:4608
    v_mfma_f32_16x16x32_bf16 v[84:87], v[120:123], v[232:235], v[84:87]
    ds_read_b128 v[148:151], v8 offset:2048
    v_mfma_f32_16x16x32_bf16 v[84:87], v[124:127], v[236:239], v[84:87]
    v_mfma_f32_16x16x32_bf16 v[84:87], v[128:131], v[240:243], v[84:87]
    ds_read_b128 v[152:155], v8 offset:4096
    v_mfma_f32_16x16x32_bf16 v[88:91], v[120:123], v[228:231], v[88:91]
    ds_read_b128 v[112:115], v1 offset:0
    v_mfma_f32_16x16x32_bf16 v[88:91], v[124:127], v[232:235], v[88:91]
    ds_read_b64_tr_b16 v[184:185], v9 offset:8192
    v_mfma_f32_16x16x32_bf16 v[88:91], v[128:131], v[236:239], v[88:91]
    ds_read_b64_tr_b16 v[200:201], v9 offset:12288
    v_mfma_f32_16x16x32_bf16 v[88:91], v[132:135], v[240:243], v[88:91]
    ds_read_b64_tr_b16 v[186:187], v9 offset:8704
    v_mfma_f32_16x16x32_bf16 v[92:95], v[124:127], v[228:231], v[92:95]
    ds_read_b64_tr_b16 v[202:203], v9 offset:12800
    v_mfma_f32_16x16x32_bf16 v[92:95], v[128:131], v[232:235], v[92:95]
    ds_read_b128 v[116:119], v1 offset:2176
    s_waitcnt lgkmcnt(11)
    v_lshlrev_b32 v244, 16, v180
    v_mfma_f32_16x16x32_bf16 v[92:95], v[132:135], v[236:239], v[92:95]
    ds_read_b64_tr_b16 v[188:189], v9 offset:16384
    s_waitcnt lgkmcnt(10)
    v_lshlrev_b32 v246, 16, v196
    v_mfma_f32_16x16x32_bf16 v[92:95], v[136:139], v[240:243], v[92:95]
    ds_read_b64_tr_b16 v[190:191], v9 offset:16896
    v_and_b32 v245, s58, v180
    v_mfma_f32_16x16x32_bf16 v[96:99], v[128:131], v[228:231], v[96:99]
    ds_read_b128 v[120:123], v1 offset:4224
    v_and_b32 v247, s58, v196
    v_mfma_f32_16x16x32_bf16 v[96:99], v[132:135], v[232:235], v[96:99]
    ds_read_b64_tr_b16 v[192:193], v9 offset:24576
    v_sub_f32 v244, v244, v246
    v_mfma_f32_16x16x32_bf16 v[96:99], v[136:139], v[236:239], v[96:99]
    ds_read_b64_tr_b16 v[194:195], v9 offset:25088
    v_sub_f32 v245, v245, v247
    v_mfma_f32_16x16x32_bf16 v[96:99], v[140:143], v[240:243], v[96:99]
    ds_read_b128 v[124:127], v1 offset:6272
    v_lshlrev_b32 v248, 16, v181
    v_mfma_f32_16x16x32_bf16 v[100:103], v[132:135], v[228:231], v[100:103]
    ds_read_b128 v[128:131], v1 offset:8320
    v_cvt_pk_bf16_f32 v212, v244, v245
    v_mfma_f32_16x16x32_bf16 v[100:103], v[136:139], v[232:235], v[100:103]
    ds_read_b128 v[132:135], v1 offset:10368
    v_lshlrev_b32 v250, 16, v197
    v_mfma_f32_16x16x32_bf16 v[100:103], v[140:143], v[236:239], v[100:103]
    v_and_b32 v249, s58, v181
    v_and_b32 v251, s58, v197
    v_mfma_f32_16x16x32_bf16 v[100:103], v[144:147], v[240:243], v[100:103]
    v_sub_f32 v248, v248, v250
    v_sub_f32 v249, v249, v251
    v_mfma_f32_16x16x32_bf16 v[104:107], v[136:139], v[228:231], v[104:107]
    v_lshlrev_b32 v244, 16, v182
    v_cvt_pk_bf16_f32 v213, v248, v249
    v_mfma_f32_16x16x32_bf16 v[104:107], v[140:143], v[232:235], v[104:107]
    s_waitcnt lgkmcnt(8)
    v_lshlrev_b32 v246, 16, v198
    v_and_b32 v245, s58, v182
    v_mfma_f32_16x16x32_bf16 v[104:107], v[144:147], v[236:239], v[104:107]
    v_and_b32 v247, s58, v198
    v_mfma_f32_16x16x32_bf16 v[104:107], v[148:151], v[240:243], v[104:107]
    v_sub_f32 v244, v244, v246
    v_mfma_f32_16x16x32_bf16 v[108:111], v[140:143], v[228:231], v[108:111]
    v_sub_f32 v245, v245, v247
    v_mfma_f32_16x16x32_bf16 v[108:111], v[144:147], v[232:235], v[108:111]
    v_cvt_pk_bf16_f32 v214, v244, v245
    s_sub_u32 s64, s64, 1
    v_mfma_f32_16x16x32_bf16 v[108:111], v[148:151], v[236:239], v[108:111]
    s_cmp_lg_u32 s64, 0
    v_mfma_f32_16x16x32_bf16 v[108:111], v[152:155], v[240:243], v[108:111]
    s_cbranch_scc1 L_body0
    s_mov_b32 s64, 4
.p2align 3
L_body1:
    v_mfma_f32_16x16x32_bf16 v[16:19], v[112:115], v[180:183], v[16:19]
    ds_read_b128 v[136:139], v1 offset:12416
    v_lshlrev_b32 v248, 16, v183
    v_mfma_f32_16x16x32_bf16 v[16:19], v[116:119], v[184:187], v[16:19]
    ds_read_b64_tr_b16 v[204:205], v9 offset:20480
    v_lshlrev_b32 v250, 16, v199
    s_waitcnt lgkmcnt(2)
    v_mfma_f32_16x16x32_bf16 v[16:19], v[120:123], v[188:191], v[16:19]
    ds_read_b64_tr_b16 v[206:207], v9 offset:20992
    v_and_b32 v249, s58, v183
    v_mfma_f32_16x16x32_bf16 v[16:19], v[124:127], v[192:195], v[16:19]
    ds_read_b128 v[140:143], v1 offset:14464
    v_and_b32 v251, s58, v199
    v_mfma_f32_16x16x32_bf16 v[20:23], v[116:119], v[180:183], v[20:23]
    ds_read_b128 v[144:147], v2 offset:0
    v_sub_f32 v248, v248, v250
    v_mfma_f32_16x16x32_bf16 v[20:23], v[120:123], v[184:187], v[20:23]
    ds_read_b128 v[148:151], v2 offset:2176
    v_sub_f32 v249, v249, v251
    v_mfma_f32_16x16x32_bf16 v[20:23], v[124:127], v[188:191], v[20:23]
    ds_read_b128 v[112:115], v1 offset:16512
    v_lshlrev_b32 v244, 16, v184
    v_mfma_f32_16x16x32_bf16 v[20:23], v[128:131], v[192:195], v[20:23]
    ds_read_b128 v[116:119], v1 offset:18560
    v_cvt_pk_bf16_f32 v215, v248, v249
    v_mfma_f32_16x16x32_bf16 v[24:27], v[120:123], v[180:183], v[24:27]
    ds_read_b128 v[120:123], v1 offset:20608
    v_lshlrev_b32 v246, 16, v200
    v_mfma_f32_16x16x32_bf16 v[24:27], v[124:127], v[184:187], v[24:27]
    ds_read_b128 v[156:159], v1 offset:26752
    v_and_b32 v245, s58, v184
    v_mfma_f32_16x16x32_bf16 v[24:27], v[128:131], v[188:191], v[24:27]
    ds_read_b128 v[160:163], v1 offset:28800
    v_and_b32 v247, s58, v200
    v_mfma_f32_16x16x32_bf16 v[24:27], v[132:135], v[192:195], v[24:27]
    ds_read_b128 v[164:167], v1 offset:30848
    v_sub_f32 v244, v244, v246
    v_mfma_f32_16x16x32_bf16 v[28:31], v[124:127], v[180:183], v[28:31]
    ds_read_b128 v[124:127], v1 offset:22656
    v_sub_f32 v245, v245, v247
    v_mfma_f32_16x16x32_bf16 v[28:31], v[128:131], v[184:187], v[28:31]
    ds_read_b128 v[168:171], v2 offset:16512
    v_lshlrev_b32 v248, 16, v185
    v_mfma_f32_16x16x32_bf16 v[28:31], v[132:135], v[188:191], v[28:31]
    ds_read_b128 v[172:175], v2 offset:18560
    v_cvt_pk_bf16_f32 v216, v244, v245
    s_waitcnt lgkmcnt(11)
    v_mfma_f32_16x16x32_bf16 v[28:31], v[136:139], v[192:195], v[28:31]
    ds_read_b128 v[152:155], v2 offset:4224
    v_lshlrev_b32 v250, 16, v201
    v_mfma_f32_16x16x32_bf16 v[32:35], v[128:131], v[180:183], v[32:35]
    ds_read_b128 v[128:131], v1 offset:24704
    v_and_b32 v249, s58, v185
    v_mfma_f32_16x16x32_bf16 v[32:35], v[132:135], v[184:187], v[32:35]
    v_and_b32 v251, s58, v201
    v_sub_f32 v248, v248, v250
    v_mfma_f32_16x16x32_bf16 v[32:35], v[136:139], v[188:191], v[32:35]
    v_sub_f32 v249, v249, v251
    v_lshlrev_b32 v244, 16, v186
    v_mfma_f32_16x16x32_bf16 v[32:35], v[140:143], v[192:195], v[32:35]
    v_cvt_pk_bf16_f32 v217, v248, v249
    v_lshlrev_b32 v246, 16, v202
    v_mfma_f32_16x16x32_bf16 v[36:39], v[132:135], v[180:183], v[36:39]
    s_barrier
    v_and_b32 v245, s58, v186
    v_mfma_f32_16x16x32_bf16 v[36:39], v[136:139], v[184:187], v[36:39]
    v_and_b32 v247, s58, v202
    v_sub_f32 v244, v244, v246
    v_mfma_f32_16x16x32_bf16 v[36:39], v[140:143], v[188:191], v[36:39]
    v_sub_f32 v245, v245, v247
    v_lshlrev_b32 v248, 16, v187
    s_waitcnt lgkmcnt(5)
    v_mfma_f32_16x16x32_bf16 v[36:39], v[144:147], v[192:195], v[36:39]
    v_cvt_pk_bf16_f32 v218, v244, v245
    v_lshlrev_b32 v250, 16, v203
    v_mfma_f32_16x16x32_bf16 v[40:43], v[136:139], v[180:183], v[40:43]
    v_and_b32 v249, s58, v187
    v_and_b32 v251, s58, v203
    v_mfma_f32_16x16x32_bf16 v[40:43], v[140:143], v[184:187], v[40:43]
    v_sub_f32 v248, v248, v250
    v_sub_f32 v249, v249, v251
    v_mfma_f32_16x16x32_bf16 v[40:43], v[144:147], v[188:191], v[40:43]
    v_lshlrev_b32 v244, 16, v188
    v_mfma_f32_16x16x32_bf16 v[40:43], v[148:151], v[192:195], v[40:43]
    v_cvt_pk_bf16_f32 v219, v248, v249
    v_lshlrev_b32 v246, 16, v204
    v_mfma_f32_16x16x32_bf16 v[44:47], v[140:143], v[180:183], v[44:47]
    v_and_b32 v245, s58, v188
    v_mfma_f32_16x16x32_bf16 v[44:47], v[144:147], v[184:187], v[44:47]
    v_and_b32 v247, s58, v204
    v_mfma_f32_16x16x32_bf16 v[44:47], v[148:151], v[188:191], v[44:47]
    v_sub_f32 v244, v244, v246
    s_waitcnt lgkmcnt(0)
    v_mfma_f32_16x16x32_bf16 v[44:47], v[152:155], v[192:195], v[44:47]
    v_sub_f32 v245, v245, v247
    v_lshlrev_b32 v248, 16, v189
    v_mfma_f32_16x16x32_bf16 v[48:51], v[112:115], v[196:199], v[48:51]
    v_cvt_pk_bf16_f32 v220, v244, v245
    v_mfma_f32_16x16x32_bf16 v[48:51], v[116:119], v[200:203], v[48:51]
    v_lshlrev_b32 v250, 16, v205
    v_mfma_f32_16x16x32_bf16 v[48:51], v[120:123], v[204:207], v[48:51]
    v_and_b32 v249, s58, v189
    v_and_b32 v251, s58, v205
    v_mfma_f32_16x16x32_bf16 v[52:55], v[116:119], v[196:199], v[52:55]
    v_sub_f32 v248, v248, v250
    v_mfma_f32_16x16x32_bf16 v[52:55], v[120:123], v[200:203], v[52:55]
    v_sub_f32 v249, v249, v251
    v_mfma_f32_16x16x32_bf16 v[52:55], v[124:127], v[204:207], v[52:55]
    v_lshlrev_b32 v244, 16, v190
    v_mfma_f32_16x16x32_bf16 v[56:59], v[120:123], v[196:199], v[56:59]
    v_cvt_pk_bf16_f32 v221, v248, v249
    v_lshlrev_b32 v246, 16, v206
    v_mfma_f32_16x16x32_bf16 v[56:59], v[124:127], v[200:203], v[56:59]
    v_and_b32 v245, s58, v190
    v_mfma_f32_16x16x32_bf16 v[56:59], v[128:131], v[204:207], v[56:59]
    v_and_b32 v247, s58, v206
    v_mfma_f32_16x16x32_bf16 v[60:63], v[124:127], v[196:199], v[60:63]
    v_sub_f32 v244, v244, v246
    v_sub_f32 v245, v245, v247
    v_mfma_f32_16x16x32_bf16 v[60:63], v[128:131], v[200:203], v[60:63]
    v_lshlrev_b32 v248, 16, v191
    v_mfma_f32_16x16x32_bf16 v[60:63], v[156:159], v[204:207], v[60:63]
    v_cvt_pk_bf16_f32 v222, v244, v245
    v_mfma_f32_16x16x32_bf16 v[64:67], v[128:131], v[196:199], v[64:67]
    v_lshlrev_b32 v250, 16, v207
    v_mfma_f32_16x16x32_bf16 v[64:67], v[156:159], v[200:203], v[64:67]
    v_and_b32 v249, s58, v191
    v_and_b32 v251, s58, v207
    v_mfma_f32_16x16x32_bf16 v[64:67], v[160:163], v[204:207], v[64:67]
    s_barrier
    ds_read_b128 v[112:115], v5 offset:0
    v_mfma_f32_16x16x32_bf16 v[68:71], v[156:159], v[196:199], v[68:71]
    ds_read_b128 v[116:119], v5 offset:2048
    v_sub_f32 v248, v248, v250
    v_mfma_f32_16x16x32_bf16 v[68:71], v[160:163], v[200:203], v[68:71]
    ds_read_b128 v[120:123], v5 offset:4096
    v_sub_f32 v249, v249, v251
    v_mfma_f32_16x16x32_bf16 v[68:71], v[164:167], v[204:207], v[68:71]
    ds_read_b128 v[124:127], v5 offset:6144
    v_cvt_pk_bf16_f32 v223, v248, v249
    v_mfma_f32_16x16x32_bf16 v[72:75], v[160:163], v[196:199], v[72:75]
    ds_read_b128 v[128:131], v5 offset:8192
    v_mov_b32 v224, v192
    v_mfma_f32_16x16x32_bf16 v[72:75], v[164:167], v[200:203], v[72:75]
    ds_read_b128 v[132:135], v5 offset:10240
    v_mov_b32 v225, v193
    v_mfma_f32_16x16x32_bf16 v[72:75], v[168:171], v[204:207], v[72:75]
    ds_read_b128 v[136:139], v5 offset:12288
    v_mov_b32 v226, v194
    v_mfma_f32_16x16x32_bf16 v[76:79], v[164:167], v[196:199], v[76:79]
    ds_read_b128 v[140:143], v5 offset:14336
    v_mov_b32 v227, v195
    v_mfma_f32_16x16x32_bf16 v[76:79], v[168:171], v[200:203], v[76:79]
    v_mfma_f32_16x16x32_bf16 v[76:79], v[172:175], v[204:207], v[76:79]
    ds_read_b128 v[144:147], v6 offset:0
    s_waitcnt lgkmcnt(8)
    v_mfma_f32_16x16x32_bf16 v[80:83], v[112:115], v[212:215], v[80:83]
    s_waitcnt lgkmcnt(7)
    v_mfma_f32_16x16x32_bf16 v[80:83], v[116:119], v[216:219], v[80:83]
    s_barrier
    ds_read_b64_tr_b16 v[180:181], v9 offset:32768
    s_waitcnt lgkmcnt(7)
    v_mfma_f32_16x16x32_bf16 v[80:83], v[120:123], v[220:223], v[80:83]
    ds_read_b64_tr_b16 v[182:183], v9 offset:33280
    s_waitcnt lgkmcnt(7)
    v_mfma_f32_16x16x32_bf16 v[80:83], v[124:127], v[224:227], v[80:83]
    ds_read_b64_tr_b16 v[196:197], v9 offset:36864
    v_mfma_f32_16x16x32_bf16 v[84:87], v[116:119], v[212:215], v[84:87]
    ds_read_b64_tr_b16 v[198:199], v9 offset:37376
    v_mfma_f32_16x16x32_bf16 v[84:87], v[120:123], v[216:219], v[84:87]
    ds_read_b128 v[148:151], v6 offset:2048
    v_mfma_f32_16x16x32_bf16 v[84:87], v[124:127], v[220:223], v[84:87]
    s_waitcnt lgkmcnt(8)
    v_mfma_f32_16x16x32_bf16 v[84:87], v[128:131], v[224:227], v[84:87]
    ds_read_b128 v[152:155], v6 offset:4096
    v_mfma_f32_16x16x32_bf16 v[88:91], v[120:123], v[212:215], v[88:91]
    ds_read_b128 v[112:115], v3 offset:0
    v_mfma_f32_16x16x32_bf16 v[88:91], v[124:127], v[216:219], v[88:91]
    ds_read_b64_tr_b16 v[184:185], v9 offset:40960
    v_mfma_f32_16x16x32_bf16 v[88:91], v[128:131], v[220:223], v[88:91]
    ds_read_b64_tr_b16 v[200:201], v9 offset:45056
    v_mfma_f32_16x16x32_bf16 v[88:91], v[132:135], v[224:227], v[88:91]
    ds_read_b64_tr_b16 v[186:187], v9 offset:41472
    v_mfma_f32_16x16x32_bf16 v[92:95], v[124:127], v[212:215], v[92:95]
    ds_read_b64_tr_b16 v[202:203], v9 offset:45568
    v_mfma_f32_16x16x32_bf16 v[92:95], v[128:131], v[216:219], v[92:95]
    ds_read_b128 v[116:119], v3 offset:2176
    s_waitcnt lgkmcnt(11)
    v_lshlrev_b32 v244, 16, v180
    v_mfma_f32_16x16x32_bf16 v[92:95], v[132:135], v[220:223], v[92:95]
    ds_read_b64_tr_b16 v[188:189], v9 offset:49152
    s_waitcnt lgkmcnt(10)
    v_lshlrev_b32 v246, 16, v196
    v_mfma_f32_16x16x32_bf16 v[92:95], v[136:139], v[224:227], v[92:95]
    ds_read_b64_tr_b16 v[190:191], v9 offset:49664
    v_and_b32 v245, s58, v180
    v_mfma_f32_16x16x32_bf16 v[96:99], v[128:131], v[212:215], v[96:99]
    ds_read_b128 v[120:123], v3 offset:4224
    v_and_b32 v247, s58, v196
    v_mfma_f32_16x16x32_bf16 v[96:99], v[132:135], v[216:219], v[96:99]
    ds_read_b64_tr_b16 v[192:193], v9 offset:57344
    v_sub_f32 v244, v244, v246
    v_mfma_f32_16x16x32_bf16 v[96:99], v[136:139], v[220:223], v[96:99]
    ds_read_b64_tr_b16 v[194:195], v9 offset:57856
    v_sub_f32 v245, v245, v247
    v_mfma_f32_16x16x32_bf16 v[96:99], v[140:143], v[224:227], v[96:99]
    ds_read_b128 v[124:127], v3 offset:6272
    v_lshlrev_b32 v248, 16, v181
    v_mfma_f32_16x16x32_bf16 v[100:103], v[132:135], v[212:215], v[100:103]
    ds_read_b128 v[128:131], v3 offset:8320
    v_cvt_pk_bf16_f32 v228, v244, v245
    v_mfma_f32_16x16x32_bf16 v[100:103], v[136:139], v[216:219], v[100:103]
    ds_read_b128 v[132:135], v3 offset:10368
    v_lshlrev_b32 v250, 16, v197
    v_mfma_f32_16x16x32_bf16 v[100:103], v[140:143], v[220:223], v[100:103]
    v_and_b32 v249, s58, v181
    v_and_b32 v251, s58, v197
    v_mfma_f32_16x16x32_bf16 v[100:103], v[144:147], v[224:227], v[100:103]
    v_sub_f32 v248, v248, v250
    v_sub_f32 v249, v249, v251
    v_mfma_f32_16x16x32_bf16 v[104:107], v[136:139], v[212:215], v[104:107]
    v_lshlrev_b32 v244, 16, v182
    v_cvt_pk_bf16_f32 v229, v248, v249
    v_mfma_f32_16x16x32_bf16 v[104:107], v[140:143], v[216:219], v[104:107]
    s_waitcnt lgkmcnt(8)
    v_lshlrev_b32 v246, 16, v198
    v_and_b32 v245, s58, v182
    v_mfma_f32_16x16x32_bf16 v[104:107], v[144:147], v[220:223], v[104:107]
    v_and_b32 v247, s58, v198
    v_mfma_f32_16x16x32_bf16 v[104:107], v[148:151], v[224:227], v[104:107]
    v_sub_f32 v244, v244, v246
    v_mfma_f32_16x16x32_bf16 v[108:111], v[140:143], v[212:215], v[108:111]
    v_sub_f32 v245, v245, v247
    v_mfma_f32_16x16x32_bf16 v[108:111], v[144:147], v[216:219], v[108:111]
    v_cvt_pk_bf16_f32 v230, v244, v245
    v_mfma_f32_16x16x32_bf16 v[108:111], v[148:151], v[220:223], v[108:111]
    v_mfma_f32_16x16x32_bf16 v[108:111], v[152:155], v[224:227], v[108:111]
    v_mfma_f32_16x16x32_bf16 v[16:19], v[112:115], v[180:183], v[16:19]
    ds_read_b128 v[136:139], v3 offset:12416
    v_lshlrev_b32 v248, 16, v183
    v_mfma_f32_16x16x32_bf16 v[16:19], v[116:119], v[184:187], v[16:19]
    ds_read_b64_tr_b16 v[204:205], v9 offset:53248
    v_lshlrev_b32 v250, 16, v199
    s_waitcnt lgkmcnt(2)
    v_mfma_f32_16x16x32_bf16 v[16:19], v[120:123], v[188:191], v[16:19]
    ds_read_b64_tr_b16 v[206:207], v9 offset:53760
    v_and_b32 v249, s58, v183
    v_mfma_f32_16x16x32_bf16 v[16:19], v[124:127], v[192:195], v[16:19]
    ds_read_b128 v[140:143], v3 offset:14464
    v_and_b32 v251, s58, v199
    v_mfma_f32_16x16x32_bf16 v[20:23], v[116:119], v[180:183], v[20:23]
    ds_read_b128 v[144:147], v4 offset:0
    v_sub_f32 v248, v248, v250
    v_mfma_f32_16x16x32_bf16 v[20:23], v[120:123], v[184:187], v[20:23]
    ds_read_b128 v[148:151], v4 offset:2176
    v_sub_f32 v249, v249, v251
    v_mfma_f32_16x16x32_bf16 v[20:23], v[124:127], v[188:191], v[20:23]
    v_lshlrev_b32 v244, 16, v184
    v_cvt_pk_bf16_f32 v231, v248, v249
    v_mfma_f32_16x16x32_bf16 v[20:23], v[128:131], v[192:195], v[20:23]
    ds_read_b128 v[152:155], v4 offset:4224
    v_lshlrev_b32 v246, 16, v200
    v_mfma_f32_16x16x32_bf16 v[24:27], v[120:123], v[180:183], v[24:27]
    ds_read_b128 v[112:115], v3 offset:16512
    v_and_b32 v245, s58, v184
    v_mfma_f32_16x16x32_bf16 v[24:27], v[124:127], v[184:187], v[24:27]
    ds_read_b128 v[116:119], v3 offset:18560
    v_and_b32 v247, s58, v200
    v_mfma_f32_16x16x32_bf16 v[24:27], v[128:131], v[188:191], v[24:27]
    ds_read_b128 v[120:123], v3 offset:20608
    v_sub_f32 v244, v244, v246
    v_mfma_f32_16x16x32_bf16 v[24:27], v[132:135], v[192:195], v[24:27]
    v_sub_f32 v245, v245, v247
    v_lshlrev_b32 v248, 16, v185
    v_mfma_f32_16x16x32_bf16 v[28:31], v[124:127], v[180:183], v[28:31]
    v_cvt_pk_bf16_f32 v232, v244, v245
    v_lshlrev_b32 v250, 16, v201
    v_mfma_f32_16x16x32_bf16 v[28:31], v[128:131], v[184:187], v[28:31]
    ds_read_b128 v[124:127], v3 offset:22656
    v_and_b32 v249, s58, v185
    v_mfma_f32_16x16x32_bf16 v[28:31], v[132:135], v[188:191], v[28:31]
    v_and_b32 v251, s58, v201
    v_sub_f32 v248, v248, v250
    s_waitcnt lgkmcnt(7)
    v_mfma_f32_16x16x32_bf16 v[28:31], v[136:139], v[192:195], v[28:31]
    v_sub_f32 v249, v249, v251
    v_lshlrev_b32 v244, 16, v186
    v_mfma_f32_16x16x32_bf16 v[32:35], v[128:131], v[180:183], v[32:35]
    ds_read_b128 v[128:131], v3 offset:24704
    v_cvt_pk_bf16_f32 v233, v248, v249
    v_mfma_f32_16x16x32_bf16 v[32:35], v[132:135], v[184:187], v[32:35]
    v_lshlrev_b32 v246, 16, v202
    v_and_b32 v245, s58, v186
    v_mfma_f32_16x16x32_bf16 v[32:35], v[136:139], v[188:191], v[32:35]
    v_and_b32 v247, s58, v202
    v_mfma_f32_16x16x32_bf16 v[32:35], v[140:143], v[192:195], v[32:35]
    ds_read_b128 v[156:159], v3 offset:26752
    v_sub_f32 v244, v244, v246
    v_mfma_f32_16x16x32_bf16 v[36:39], v[132:135], v[180:183], v[36:39]
    s_barrier
    v_sub_f32 v245, v245, v247
    v_mfma_f32_16x16x32_bf16 v[36:39], v[136:139], v[184:187], v[36:39]
    v_lshlrev_b32 v248, 16, v187
    v_cvt_pk_bf16_f32 v234, v244, v245
    v_mfma_f32_16x16x32_bf16 v[36:39], v[140:143], v[188:191], v[36:39]
    ds_read_b128 v[160:163], v3 offset:28800
    v_lshlrev_b32 v250, 16, v203
    s_waitcnt lgkmcnt(4)
    v_mfma_f32_16x16x32_bf16 v[36:39], v[144:147], v[192:195], v[36:39]
    v_and_b32 v249, s58, v187
    v_mfma_f32_16x16x32_bf16 v[40:43], v[136:139], v[180:183], v[40:43]
    v_and_b32 v251, s58, v203
    v_sub_f32 v248, v248, v250
    v_mfma_f32_16x16x32_bf16 v[40:43], v[140:143], v[184:187], v[40:43]
    ds_read_b128 v[164:167], v3 offset:30848
    v_sub_f32 v249, v249, v251
    v_mfma_f32_16x16x32_bf16 v[40:43], v[144:147], v[188:191], v[40:43]
    v_lshlrev_b32 v244, 16, v188
    v_mfma_f32_16x16x32_bf16 v[40:43], v[148:151], v[192:195], v[40:43]
    v_cvt_pk_bf16_f32 v235, v248, v249
    v_lshlrev_b32 v246, 16, v204
    v_mfma_f32_16x16x32_bf16 v[44:47], v[140:143], v[180:183], v[44:47]
    ds_read_b128 v[168:171], v4 offset:16512
    v_and_b32 v245, s58, v188
    v_mfma_f32_16x16x32_bf16 v[44:47], v[144:147], v[184:187], v[44:47]
    v_and_b32 v247, s58, v204
    v_mfma_f32_16x16x32_bf16 v[44:47], v[148:151], v[188:191], v[44:47]
    v_sub_f32 v244, v244, v246
    v_mfma_f32_16x16x32_bf16 v[44:47], v[152:155], v[192:195], v[44:47]
    ds_read_b128 v[172:175], v4 offset:18560
    v_sub_f32 v245, v245, v247
    v_mfma_f32_16x16x32_bf16 v[48:51], v[112:115], v[196:199], v[48:51]
    ds_read_b128 v[112:115], v7 offset:0
    v_lshlrev_b32 v248, 16, v189
    v_mfma_f32_16x16x32_bf16 v[48:51], v[116:119], v[200:203], v[48:51]
    v_cvt_pk_bf16_f32 v236, v244, v245
    v_lshlrev_b32 v250, 16, v205
    v_mfma_f32_16x16x32_bf16 v[48:51], v[120:123], v[204:207], v[48:51]
    v_and_b32 v249, s58, v189
    v_and_b32 v251, s58, v205
    v_mfma_f32_16x16x32_bf16 v[52:55], v[116:119], v[196:199], v[52:55]
    ds_read_b128 v[116:119], v7 offset:2048
    v_sub_f32 v248, v248, v250
    v_mfma_f32_16x16x32_bf16 v[52:55], v[120:123], v[200:203], v[52:55]
    v_sub_f32 v249, v249, v251
    s_waitcnt lgkmcnt(4)
    v_mfma_f32_16x16x32_bf16 v[52:55], v[124:127], v[204:207], v[52:55]
    v_lshlrev_b32 v244, 16, v190
    v_mfma_f32_16x16x32_bf16 v[56:59], v[120:123], v[196:199], v[56:59]
    ds_read_b128 v[120:123], v7 offset:4096
    v_cvt_pk_bf16_f32 v237, v248, v249
    v_mfma_f32_16x16x32_bf16 v[56:59], v[124:127], v[200:203], v[56:59]
    v_lshlrev_b32 v246, 16, v206
    v_and_b32 v245, s58, v190
    v_mfma_f32_16x16x32_bf16 v[56:59], v[128:131], v[204:207], v[56:59]
    v_and_b32 v247, s58, v206
    v_mfma_f32_16x16x32_bf16 v[60:63], v[124:127], v[196:199], v[60:63]
    ds_read_b128 v[124:127], v7 offset:6144
    v_sub_f32 v244, v244, v246
    v_mfma_f32_16x16x32_bf16 v[60:63], v[128:131], v[200:203], v[60:63]
    v_sub_f32 v245, v245, v247
    v_lshlrev_b32 v248, 16, v191
    v_mfma_f32_16x16x32_bf16 v[60:63], v[156:159], v[204:207], v[60:63]
    ds_read_b128 v[132:135], v7 offset:10240
    v_cvt_pk_bf16_f32 v238, v244, v245
    v_mfma_f32_16x16x32_bf16 v[64:67], v[128:131], v[196:199], v[64:67]
    ds_read_b128 v[128:131], v7 offset:8192
    v_lshlrev_b32 v250, 16, v207
    v_mfma_f32_16x16x32_bf16 v[64:67], v[156:159], v[200:203], v[64:67]
    v_and_b32 v249, s58, v191
    v_and_b32 v251, s58, v207
    v_mfma_f32_16x16x32_bf16 v[64:67], v[160:163], v[204:207], v[64:67]
    v_sub_f32 v248, v248, v250
    v_mfma_f32_16x16x32_bf16 v[68:71], v[156:159], v[196:199], v[68:71]
    ds_read_b128 v[136:139], v7 offset:12288
    v_sub_f32 v249, v249, v251
    v_mfma_f32_16x16x32_bf16 v[68:71], v[160:163], v[200:203], v[68:71]
    v_cvt_pk_bf16_f32 v239, v248, v249
    s_sub_u32 s62, 0, s62
    v_mfma_f32_16x16x32_bf16 v[68:71], v[164:167], v[204:207], v[68:71]
    v_mov_b32 v240, v192
    v_add_u32 v1, s62, v1
    v_mfma_f32_16x16x32_bf16 v[72:75], v[160:163], v[196:199], v[72:75]
    v_mov_b32 v241, v193
    v_mov_b32 v242, v194
    v_mfma_f32_16x16x32_bf16 v[72:75], v[164:167], v[200:203], v[72:75]
    ds_read_b128 v[140:143], v7 offset:14336
    v_add_u32 v2, s62, v2
    s_waitcnt lgkmcnt(5)
    v_mfma_f32_16x16x32_bf16 v[72:75], v[168:171], v[204:207], v[72:75]
    v_mov_b32 v243, v195
    v_mfma_f32_16x16x32_bf16 v[76:79], v[164:167], v[196:199], v[76:79]
    v_add_u32 v3, s62, v3
    v_mfma_f32_16x16x32_bf16 v[76:79], v[168:171], v[200:203], v[76:79]
    v_mfma_f32_16x16x32_bf16 v[76:79], v[172:175], v[204:207], v[76:79]
    ds_read_b128 v[144:147], v8 offset:0
    v_add_u32 v4, s62, v4
    v_mfma_f32_16x16x32_bf16 v[80:83], v[112:115], v[228:231], v[80:83]
    v_mfma_f32_16x16x32_bf16 v[80:83], v[116:119], v[232:235], v[80:83]
    s_barrier
    ds_read_b64_tr_b16 v[180:181], v9 offset:0
    v_mfma_f32_16x16x32_bf16 v[80:83], v[120:123], v[236:239], v[80:83]
    ds_read_b64_tr_b16 v[182:183], v9 offset:512
    s_waitcnt lgkmcnt(4)
    v_mfma_f32_16x16x32_bf16 v[80:83], v[124:127], v[240:243], v[80:83]
    ds_read_b64_tr_b16 v[196:197], v9 offset:4096
    v_mfma_f32_16x16x32_bf16 v[84:87], v[116:119], v[228:231], v[84:87]
    ds_read_b64_tr_b16 v[198:199], v9 offset:4608
    v_mfma_f32_16x16x32_bf16 v[84:87], v[120:123], v[232:235], v[84:87]
    ds_read_b128 v[148:151], v8 offset:2048
    v_mfma_f32_16x16x32_bf16 v[84:87], v[124:127], v[236:239], v[84:87]
    v_mfma_f32_16x16x32_bf16 v[84:87], v[128:131], v[240:243], v[84:87]
    ds_read_b128 v[152:155], v8 offset:4096
    v_mfma_f32_16x16x32_bf16 v[88:91], v[120:123], v[228:231], v[88:91]
    ds_read_b128 v[112:115], v1 offset:0
    v_mfma_f32_16x16x32_bf16 v[88:91], v[124:127], v[232:235], v[88:91]
    ds_read_b64_tr_b16 v[184:185], v9 offset:8192
    v_mfma_f32_16x16x32_bf16 v[88:91], v[128:131], v[236:239], v[88:91]
    ds_read_b64_tr_b16 v[200:201], v9 offset:12288
    v_mfma_f32_16x16x32_bf16 v[88:91], v[132:135], v[240:243], v[88:91]
    ds_read_b64_tr_b16 v[186:187], v9 offset:8704
    v_mfma_f32_16x16x32_bf16 v[92:95], v[124:127], v[228:231], v[92:95]
    ds_read_b64_tr_b16 v[202:203], v9 offset:12800
    v_mfma_f32_16x16x32_bf16 v[92:95], v[128:131], v[232:235], v[92:95]
    ds_read_b128 v[116:119], v1 offset:2176
    s_waitcnt lgkmcnt(11)
    v_lshlrev_b32 v244, 16, v180
    v_mfma_f32_16x16x32_bf16 v[92:95], v[132:135], v[236:239], v[92:95]
    ds_read_b64_tr_b16 v[188:189], v9 offset:16384
    s_waitcnt lgkmcnt(10)
    v_lshlrev_b32 v246, 16, v196
    v_mfma_f32_16x16x32_bf16 v[92:95], v[136:139], v[240:243], v[92:95]
    ds_read_b64_tr_b16 v[190:191], v9 offset:16896
    v_and_b32 v245, s58, v180
    v_mfma_f32_16x16x32_bf16 v[96:99], v[128:131], v[228:231], v[96:99]
    ds_read_b128 v[120:123], v1 offset:4224
    v_and_b32 v247, s58, v196
    v_mfma_f32_16x16x32_bf16 v[96:99], v[132:135], v[232:235], v[96:99]
    ds_read_b64_tr_b16 v[192:193], v9 offset:24576
    v_sub_f32 v244, v244, v246
    v_mfma_f32_16x16x32_bf16 v[96:99], v[136:139], v[236:239], v[96:99]
    ds_read_b64_tr_b16 v[194:195], v9 offset:25088
    v_sub_f32 v245, v245, v247
    v_mfma_f32_16x16x32_bf16 v[96:99], v[140:143], v[240:243], v[96:99]
    ds_read_b128 v[124:127], v1 offset:6272
    v_lshlrev_b32 v248, 16, v181
    v_mfma_f32_16x16x32_bf16 v[100:103], v[132:135], v[228:231], v[100:103]
    ds_read_b128 v[128:131], v1 offset:8320
    v_cvt_pk_bf16_f32 v212, v244, v245
    v_mfma_f32_16x16x32_bf16 v[100:103], v[136:139], v[232:235], v[100:103]
    ds_read_b128 v[132:135], v1 offset:10368
    v_lshlrev_b32 v250, 16, v197
    v_mfma_f32_16x16x32_bf16 v[100:103], v[140:143], v[236:239], v[100:103]
    v_and_b32 v249, s58, v181
    v_and_b32 v251, s58, v197
    v_mfma_f32_16x16x32_bf16 v[100:103], v[144:147], v[240:243], v[100:103]
    v_sub_f32 v248, v248, v250
    v_sub_f32 v249, v249, v251
    v_mfma_f32_16x16x32_bf16 v[104:107], v[136:139], v[228:231], v[104:107]
    v_lshlrev_b32 v244, 16, v182
    v_cvt_pk_bf16_f32 v213, v248, v249
    v_mfma_f32_16x16x32_bf16 v[104:107], v[140:143], v[232:235], v[104:107]
    s_waitcnt lgkmcnt(8)
    v_lshlrev_b32 v246, 16, v198
    v_and_b32 v245, s58, v182
    v_mfma_f32_16x16x32_bf16 v[104:107], v[144:147], v[236:239], v[104:107]
    v_and_b32 v247, s58, v198
    v_mfma_f32_16x16x32_bf16 v[104:107], v[148:151], v[240:243], v[104:107]
    v_sub_f32 v244, v244, v246
    v_mfma_f32_16x16x32_bf16 v[108:111], v[140:143], v[228:231], v[108:111]
    v_sub_f32 v245, v245, v247
    v_mfma_f32_16x16x32_bf16 v[108:111], v[144:147], v[232:235], v[108:111]
    v_cvt_pk_bf16_f32 v214, v244, v245
    s_sub_u32 s64, s64, 1
    v_mfma_f32_16x16x32_bf16 v[108:111], v[148:151], v[236:239], v[108:111]
    s_cmp_lg_u32 s64, 0
    v_mfma_f32_16x16x32_bf16 v[108:111], v[152:155], v[240:243], v[108:111]
    s_cbranch_scc1 L_body1
L_epi:
    ds_bpermute_b32 v244, v10, v16
    v_pk_add_f32 v[212:213], v[16:17], v[48:49]
    v_pk_add_f32 v[214:215], v[18:19], v[50:51]
    v_pk_add_f32 v[216:217], v[20:21], v[52:53]
    v_pk_add_f32 v[218:219], v[22:23], v[54:55]
    v_pk_add_f32 v[220:221], v[24:25], v[56:57]
    v_pk_add_f32 v[222:223], v[26:27], v[58:59]
    v_pk_add_f32 v[224:225], v[28:29], v[60:61]
    v_pk_add_f32 v[226:227], v[30:31], v[62:63]
    v_pk_add_f32 v[228:229], v[32:33], v[64:65]
    v_pk_add_f32 v[230:231], v[34:35], v[66:67]
    v_pk_add_f32 v[232:233], v[36:37], v[68:69]
    v_pk_add_f32 v[234:235], v[38:39], v[70:71]
    v_pk_add_f32 v[236:237], v[40:41], v[72:73]
    v_pk_add_f32 v[238:239], v[42:43], v[74:75]
    v_pk_add_f32 v[240:241], v[44:45], v[76:77]
    v_pk_add_f32 v[242:243], v[46:47], v[78:79]
    v_pk_add_f32 v[48:49], v[48:49], v[20:21]
    v_pk_add_f32 v[50:51], v[50:51], v[22:23]
    v_pk_add_f32 v[52:53], v[52:53], v[24:25]
    v_pk_add_f32 v[54:55], v[54:55], v[26:27]
    v_pk_add_f32 v[56:57], v[56:57], v[28:29]
    v_pk_add_f32 v[58:59], v[58:59], v[30:31]
    v_pk_add_f32 v[60:61], v[60:61], v[32:33]
    v_pk_add_f32 v[62:63], v[62:63], v[34:35]
    v_pk_add_f32 v[64:65], v[64:65], v[36:37]
    v_pk_add_f32 v[66:67], v[66:67], v[38:39]
    v_pk_add_f32 v[68:69], v[68:69], v[40:41]
    v_pk_add_f32 v[70:71], v[70:71], v[42:43]
    v_pk_add_f32 v[72:73], v[72:73], v[44:45]
    v_pk_add_f32 v[74:75], v[74:75], v[46:47]
    v_add_f32 v76, v76, v17
    v_add_f32 v77, v77, v18
    v_add_f32 v78, v78, v19
    s_cmp_lg_u32 s53, 31
    s_mov_b32 exec_lo, 0
    s_mov_b32 exec_hi, 0xffff0000
    v_mov_b32 v235, 0
    v_mov_b32 v239, 0
    v_mov_b32 v243, 0
    s_cbranch_scc0 L_nolast0_x
L_nolast0:
    s_mov_b64 exec, -1
    v_pk_mul_f32 v[164:165], v[212:213], v[212:213]
    v_pk_mul_f32 v[166:167], v[214:215], v[214:215]
    v_pk_mul_f32 v[168:169], v[216:217], v[216:217]
    v_pk_mul_f32 v[170:171], v[218:219], v[218:219]
    v_pk_add_f32 v[156:157], v[212:213], v[220:221]
    v_pk_fma_f32 v[164:165], v[220:221], v[220:221], v[164:165]
    v_pk_add_f32 v[158:159], v[214:215], v[222:223]
    v_pk_fma_f32 v[166:167], v[222:223], v[222:223], v[166:167]
    v_pk_add_f32 v[160:161], v[216:217], v[224:225]
    v_pk_fma_f32 v[168:169], v[224:225], v[224:225], v[168:169]
    v_pk_add_f32 v[162:163], v[218:219], v[226:227]
    v_pk_fma_f32 v[170:171], v[226:227], v[226:227], v[170:171]
    v_pk_add_f32 v[156:157], v[156:157], v[228:229]
    v_pk_fma_f32 v[164:165], v[228:229], v[228:229], v[164:165]
    v_pk_add_f32 v[158:159], v[158:159], v[230:231]
    v_pk_fma_f32 v[166:167], v[230:231], v[230:231], v[166:167]
    v_pk_add_f32 v[160:161], v[160:161], v[232:233]
    v_pk_fma_f32 v[168:169], v[232:233], v[232:233], v[168:169]
    v_pk_add_f32 v[162:163], v[162:163], v[234:235]
    v_pk_fma_f32 v[170:171], v[234:235], v[234:235], v[170:171]
    v_pk_add_f32 v[156:157], v[156:157], v[236:237]
    v_pk_fma_f32 v[164:165], v[236:237], v[236:237], v[164:165]
    v_pk_add_f32 v[158:159], v[158:159], v[238:239]
    v_pk_fma_f32 v[166:167], v[238:239], v[238:239], v[166:167]
    v_pk_add_f32 v[160:161], v[160:161], v[240:241]
    v_pk_fma_f32 v[168:169], v[240:241], v[240:241], v[168:169]
    v_pk_add_f32 v[162:163], v[162:163], v[242:243]
    v_pk_fma_f32 v[170:171], v[242:243], v[242:243], v[170:171]
    s_waitcnt lgkmcnt(0)
    v_add_f32 v79, v79, v244
    v_pk_add_f32 v[80:81], v[80:81], v[48:49]
    v_pk_add_f32 v[82:83], v[82:83], v[50:51]
    v_pk_add_f32 v[84:85], v[84:85], v[52:53]
    v_pk_add_f32 v[86:87], v[86:87], v[54:55]
    v_pk_add_f32 v[88:89], v[88:89], v[56:57]
    v_pk_add_f32 v[90:91], v[90:91], v[58:59]
    v_pk_add_f32 v[92:93], v[92:93], v[60:61]
    v_pk_add_f32 v[94:95], v[94:95], v[62:63]
    v_pk_add_f32 v[96:97], v[96:97], v[64:65]
    v_pk_add_f32 v[98:99], v[98:99], v[66:67]
    v_pk_add_f32 v[100:101], v[100:101], v[68:69]
    v_pk_add_f32 v[102:103], v[102:103], v[70:71]
    v_pk_add_f32 v[104:105], v[104:105], v[72:73]
    v_pk_add_f32 v[106:107], v[106:107], v[74:75]
    v_pk_add_f32 v[108:109], v[108:109], v[76:77]
    v_pk_add_f32 v[110:111], v[110:111], v[78:79]
    s_mov_b32 exec_lo, 0
    s_mov_b32 exec_hi, 0xffff0000
    v_mov_b32 v103, 0
    v_mov_b32 v107, 0
    v_mov_b32 v111, 0
    s_cbranch_scc0 L_nolast1_x
L_nolast1:
    s_mov_b64 exec, -1
    v_pk_add_f32 v[156:157], v[156:157], v[80:81]
    v_pk_fma_f32 v[164:165], v[80:81], v[80:81], v[164:165]
    v_pk_add_f32 v[158:159], v[158:159], v[82:83]
    v_pk_fma_f32 v[166:167], v[82:83], v[82:83], v[166:167]
    v_pk_add_f32 v[160:161], v[160:161], v[84:85]
    v_pk_fma_f32 v[168:169], v[84:85], v[84:85], v[168:169]
    v_pk_add_f32 v[162:163], v[162:163], v[86:87]
    v_pk_fma_f32 v[170:171], v[86:87], v[86:87], v[170:171]
    v_pk_add_f32 v[156:157], v[156:157], v[88:89]
    v_pk_fma_f32 v[164:165], v[88:89], v[88:89], v[164:165]
    v_pk_add_f32 v[158:159], v[158:159], v[90:91]
    v_pk_fma_f32 v[166:167], v[90:91], v[90:91], v[166:167]
    v_pk_add_f32 v[160:161], v[160:161], v[92:93]
    v_pk_fma_f32 v[168:169], v[92:93], v[92:93], v[168:169]
    v_pk_add_f32 v[162:163], v[162:163], v[94:95]
    v_pk_fma_f32 v[170:171], v[94:95], v[94:95], v[170:171]
    v_pk_add_f32 v[156:157], v[156:157], v[96:97]
    v_pk_fma_f32 v[164:165], v[96:97], v[96:97], v[164:165]
    v_pk_add_f32 v[158:159], v[158:159], v[98:99]
    v_pk_fma_f32 v[166:167], v[98:99], v[98:99], v[166:167]
    v_pk_add_f32 v[160:161], v[160:161], v[100:101]
    v_pk_fma_f32 v[168:169], v[100:101], v[100:101], v[168:169]
    v_pk_add_f32 v[162:163], v[162:163], v[102:103]
    v_pk_fma_f32 v[170:171], v[102:103], v[102:103], v[170:171]
    v_pk_add_f32 v[156:157], v[156:157], v[104:105]
    v_pk_fma_f32 v[164:165], v[104:105], v[104:105], v[164:165]
    v_pk_add_f32 v[158:159], v[158:159], v[106:107]
    v_pk_fma_f32 v[166:167], v[106:107], v[106:107], v[166:167]
    v_pk_add_f32 v[160:161], v[160:161], v[108:109]
    v_pk_fma_f32 v[168:169], v[108:109], v[108:109], v[168:169]
    v_pk_add_f32 v[162:163], v[162:163], v[110:111]
    v_pk_fma_f32 v[170:171], v[110:111], v[110:111], v[170:171]
    v_pk_add_f32 v[156:157], v[156:157], v[158:159]
    v_pk_add_f32 v[164:165], v[164:165], v[166:167]
    v_pk_add_f32 v[160:161], v[160:161], v[162:163]
    v_pk_add_f32 v[168:169], v[168:169], v[170:171]
    v_pk_add_f32 v[156:157], v[156:157], v[160:161]
    v_pk_add_f32 v[164:165], v[164:165], v[168:169]
    v_add_f32 v14, v156, v157
    v_add_f32 v15, v164, v165
    s_mul_i32 s56, s50, 17472
    s_mov_b32 m0, s56
    v_permlane32_swap_b32 v14, v15
    v_add_f32 v14, v14, v15
    v_mov_b32 v15, v14
    s_nop 1
    v_permlane16_swap_b32 v14, v15
    v_add_f32 v14, v14, v15
    v_mov_b32 v15, v14
    s_nop 1
    v_permlane32_swap_b32 v14, v15
    v_and_b32 v15, 0x7fffffff, v15
    s_mov_b64 exec, 0xffff
    buffer_store_dwordx2 v[14:15], v13, s[32:35], 0 offen sc1
    s_mov_b64 exec, -1
    s_barrier
    ds_write_addtid_b32 v212 offset:0
    ds_write_addtid_b32 v213 offset:2176
    ds_write_addtid_b32 v214 offset:8704
    ds_write_addtid_b32 v215 offset:10880
    ds_write_addtid_b32 v80 offset:4352
    ds_write_addtid_b32 v81 offset:6528
    ds_write_addtid_b32 v82 offset:13056
    ds_write_addtid_b32 v83 offset:15232
    ds_write_addtid_b32 v216 offset:272
    ds_write_addtid_b32 v217 offset:2448
    ds_write_addtid_b32 v218 offset:8976
    ds_write_addtid_b32 v219 offset:11152
    ds_write_addtid_b32 v84 offset:4624
    ds_write_addtid_b32 v85 offset:6800
    ds_write_addtid_b32 v86 offset:13328
    ds_write_addtid_b32 v87 offset:15504
    ds_write_addtid_b32 v220 offset:544
    ds_write_addtid_b32 v221 offset:2720
    ds_write_addtid_b32 v222 offset:9248
    ds_write_addtid_b32 v223 offset:11424
    ds_write_addtid_b32 v88 offset:4896
    ds_write_addtid_b32 v89 offset:7072
    ds_write_addtid_b32 v90 offset:13600
    ds_write_addtid_b32 v91 offset:15776
    ds_write_addtid_b32 v224 offset:816
    ds_write_addtid_b32 v225 offset:2992
    ds_write_addtid_b32 v226 offset:9520
    ds_write_addtid_b32 v227 offset:11696
    ds_write_addtid_b32 v92 offset:5168
    ds_write_addtid_b32 v93 offset:7344
    ds_write_addtid_b32 v94 offset:13872
    ds_write_addtid_b32 v95 offset:16048
    ds_write_addtid_b32 v228 offset:1088
    ds_write_addtid_b32 v229 offset:3264
    ds_write_addtid_b32 v230 offset:9792
    ds_write_addtid_b32 v231 offset:11968
    ds_write_addtid_b32 v96 offset:5440
    ds_write_addtid_b32 v97 offset:7616
    ds_write_addtid_b32 v98 offset:14144
    ds_write_addtid_b32 v99 offset:16320
    ds_write_addtid_b32 v232 offset:1360
    ds_write_addtid_b32 v233 offset:3536
    ds_write_addtid_b32 v234 offset:10064
    ds_write_addtid_b32 v235 offset:12240
    ds_write_addtid_b32 v100 offset:5712
    ds_write_addtid_b32 v101 offset:7888
    ds_write_addtid_b32 v102 offset:14416
    ds_write_addtid_b32 v103 offset:16592
    ds_write_addtid_b32 v236 offset:1632
    ds_write_addtid_b32 v237 offset:3808
    ds_write_addtid_b32 v238 offset:10336
    ds_write_addtid_b32 v239 offset:12512
    ds_write_addtid_b32 v104 offset:5984
    ds_write_addtid_b32 v105 offset:8160
    ds_write_addtid_b32 v106 offset:14688
    ds_write_addtid_b32 v107 offset:16864
    ds_write_addtid_b32 v240 offset:1904
    ds_write_addtid_b32 v241 offset:4080
    ds_write_addtid_b32 v242 offset:10608
    ds_write_addtid_b32 v243 offset:12784
    ds_write_addtid_b32 v108 offset:6256
    ds_write_addtid_b32 v109 offset:8432
    ds_write_addtid_b32 v110 offset:14960
    ds_write_addtid_b32 v111 offset:17136
    s_waitcnt lgkmcnt(0)
    s_barrier
    v_lshrrev_b32 v20, 3, v0
    v_and_b32 v21, 7, v0
    v_lshrrev_b32 v22, 1, v20
    v_and_b32 v23, 1, v20
    v_lshl_add_u32 v22, v23, 4, v22
    v_mul_u32_u24 v22, 272, v22
    v_lshrrev_b32 v23, 1, v21
    v_mul_u32_u24 v23, 17472, v23
    v_add_u32 v22, v22, v23
    v_and_b32 v23, 1, v21
    v_lshl_add_u32 v22, v23, 5, v22
    s_and_b32 s56, s3, 1
    s_mul_i32 s56, s56, 8704
    s_lshr_b32 s57, s3, 1
    s_lshl_b32 s57, s57, 6
    s_add_u32 s56, s56, s57
    v_add_u32 v22, s56, v22
    ds_read_b128 v[64:67], v22 offset:0
    ds_read_b128 v[68:71], v22 offset:16
    ds_read_b128 v[72:75], v22 offset:1088
    ds_read_b128 v[76:79], v22 offset:1104
    ds_read_b128 v[80:83], v22 offset:2176
    ds_read_b128 v[84:87], v22 offset:2192
    ds_read_b128 v[88:91], v22 offset:3264
    ds_read_b128 v[92:95], v22 offset:3280
    s_lshl_b32 s56, s3, 5
    v_add_u32 v20, s56, v20
    v_lshlrev_b32 v23, 9, v20
    v_lshl_add_u32 v23, v21, 4, v23
    v_add_u32 v23, s51, v23
    v_lshlrev_b32 v24, 5, v21
    v_add_u32 v24, 148096, v24
    s_mov_b32 s66, 0xc09d30fc
    s_mov_b32 s67, s66
    s_mov_b32 s68, 0x3eeff558
    s_mov_b32 s69, s68
    s_branch L_final
L_nolast0_x:
    v_mov_b32 v223, 0
    v_mov_b32 v227, 0
    v_mov_b32 v231, 0
    s_branch L_nolast0
L_nolast1_x:
    v_mov_b32 v87, 0
    v_mov_b32 v91, 0
    v_mov_b32 v95, 0
    v_mov_b32 v99, 0
    s_branch L_nolast1
L_helper:
    s_mov_b32 s64, 32768
    s_mov_b32 s65, 128
    v_lshrrev_b32 v15, 3, v0
    s_lshl_b32 s56, s50, 3
    v_add_u32 v1, s56, v15
    v_bfe_u32 v15, v0, 4, 1
    s_and_b32 s56, s50, 1
    s_lshl_b32 s56, s56, 1
    v_or_b32 v15, s56, v15
    v_lshlrev_b32 v15, 1, v15
    v_and_b32 v14, 7, v0
    v_xor_b32 v15, v15, v14
    v_lshlrev_b32 v15, 4, v15
    v_lshl_add_u32 v1, v1, 9, v15
    s_sub_u32 s26, 1966080, s51
    s_mov_b32 s27, 0x20000
    s_add_u32 s24, s6, s51
    s_addc_u32 s25, s7, 0
    s_mul_i32 s56, s52, 7993
    s_add_u32 s56, s56, s55
    s_lshl_b32 s56, s56, 9
    s_add_u32 s28, s14, s56
    s_addc_u32 s29, s15, 0
    s_sub_u32 s30, 7993, s55
    s_min_u32 s30, s30, 250
    s_lshl_b32 s30, s30, 9
    s_mov_b32 s31, 0x20000
    s_mov_b32 s32, s18
    s_mov_b32 s33, s19
    s_mov_b32 s34, 0x200000
    s_mov_b32 s35, 0x20000
    s_mov_b32 s36, s16
    s_mov_b32 s37, s17
    s_mov_b32 s38, 256
    s_mov_b32 s39, 0x20000
    s_lshl_b32 s48, s52, 2
    s_add_u32 s48, s48, s54
    s_lshl_b32 s48, s48, 14
    s_lshl_b32 s49, s53, 9
    s_add_u32 s49, s49, s48
    s_mov_b32 s16, s10
    s_mov_b32 s17, s11
    s_mov_b32 s18, 512
    s_mov_b32 s19, 0x20000
    s_mov_b32 s47, 0x20000
    v_and_b32 v112, 7, v0
    v_lshrrev_b32 v113, 5, v0
    v_lshl_add_u32 v112, v112, 1, v113
    s_lshl_b32 s56, s50, 4
    v_add_u32 v112, s56, v112
    v_lshl_add_u32 v113, v112, 1, s51
    s_mov_b32 s44, s20
    s_mov_b32 s45, s21
    s_mov_b32 s46, s22
    s_cmp_eq_u32 s50, 0
    s_cselect_b32 s57, 128, 0
    s_cselect_b32 s8, s46, 0
    s_lshl_b32 s56, s54, 16
    s_add_u32 s56, s56, s57
    s_add_u32 s56, s56, 256
    v_lshl_add_u32 v19, v0, 10, s56
    s_mov_b32 s63, 128
    s_bitcmp0_b32 s50, 0
    s_cbranch_scc1 L_pfj
    s_mov_b32 s44, s6
    s_mov_b32 s45, s7
    s_cmp_eq_u32 s50, 1
    s_cselect_b32 s46, 1966080, 0
    s_mov_b32 s8, s46
    s_lshr_b32 s57, s2, 3
    s_lshr_b32 s56, s57, 2
    s_lshl_b32 s56, s56, 18
    s_and_b32 s57, s57, 3
    s_lshl_b32 s57, s57, 13
    s_add_u32 s56, s56, s57
    s_add_u32 s56, s56, 65536
    v_lshl_add_u32 v19, v0, 7, s56
    s_mov_b32 s63, 32768
    s_cmp_eq_u32 s50, 1
    s_cbranch_scc1 L_pfj
    s_getpc_b64 s[44:45]
L_pc1:
    s_sub_u32 s44, s44, L_pc1 - L_body1
    s_subb_u32 s45, s45, 0
    s_mov_b32 s46, L_helper - L_body1
    s_mov_b32 s8, s46
    v_lshlrev_b32 v19, 7, v0
    s_mov_b32 s63, 0
L_pfj:
    s_cmp_eq_u32 s50, 2
    s_cselect_b32 s9, s46, 0
    s_mov_b32 s4, 0xeac4b931
    s_mov_b32 s5, 0x6820fd75
    v_and_b32 v20, 60, v0
    v_lshrrev_b64 v[20:21], v20, s[4:5]
    v_and_b32 v20, 15, v20
    v_and_b32 v26, 15, v0
    v_lshlrev_b32 v28, 2, v26
    v_lshrrev_b64 v[28:29], v28, s[4:5]
    v_and_b32 v28, 15, v28
    s_mov_b32 s4, 0x35221100
    s_mov_b32 s5, 0x77625744
    v_and_b32 v21, 3, v0
    v_lshrrev_b32 v27, 4, v0
    v_and_b32 v22, 15, v20
    v_lshlrev_b32 v22, 2, v22
    v_lshrrev_b64 v[22:23], v22, s[4:5]
    v_and_b32 v22, 7, v22
    v_xor_b32 v22, v22, v21
    v_lshlrev_b32 v22, 4, v22
    v_lshl_add_u32 v30, v20, 7, v22
    v_and_b32 v22, 15, v28
    v_lshlrev_b32 v22, 2, v22
    v_lshrrev_b64 v[22:23], v22, s[4:5]
    v_and_b32 v22, 7, v22
    v_xor_b32 v22, v22, v27
    v_lshlrev_b32 v22, 4, v22
    v_lshl_add_u32 v31, v28, 7, v22
    s_lshl_b32 s56, s50, 12
    s_add_u32 s57, s56, 16512
    v_add_u32 v10, s57, v30
    s_add_u32 s57, s56, 2176
    v_add_u32 v12, s57, v30
    v_add_u32 v13, 2048, v12
    s_add_u32 s57, s56, 65792
    v_add_u32 v16, s57, v31
    s_cmp_lg_u32 s50, 3
    s_cbranch_scc1 L_nowrap
    v_add_u32 v20, 1, v20
    v_and_b32 v22, 15, v20
    v_lshlrev_b32 v22, 2, v22
    v_lshrrev_b64 v[22:23], v22, s[4:5]
    v_and_b32 v22, 7, v22
    v_xor_b32 v22, v22, v21
    v_lshlrev_b32 v22, 4, v22
    v_lshl_add_u32 v13, v20, 7, v22
L_nowrap:
    v_xor_b32 v11, 64, v10
    v_xor_b32 v14, 64, v12
    v_xor_b32 v15, 64, v13
    v_xor_b32 v17, 64, v16
    v_and_b32 v20, 1, v0
    v_lshlrev_b32 v20, 4, v20
    s_movk_i32 s56, 0x3f80
    v_lshlrev_b32 v20, v20, s56
    v_bfe_u32 v21, v0, 1, 3
    v_lshlrev_b32 v27, 1, v27
    v_cmp_eq_u32 vcc, v21, v27
    s_nop 1
    v_cndmask_b32 v24, 0, v20, vcc
    v_lshlrev_b32 v23, 3, v24
    v_and_b32 v23, 0x80008000, v23
    v_or_b32 v26, v24, v23
    v_add_u32 v27, 1, v27
    v_cmp_eq_u32 vcc, v21, v27
    s_nop 1
    v_cndmask_b32 v25, 0, v20, vcc
    v_lshlrev_b32 v23, 3, v25
    v_and_b32 v23, 0x80008000, v23
    v_or_b32 v27, v25, v23
    s_mov_b32 s61, 0
    s_add_u32 m0, s68, 0
    s_nop 0
    buffer_load_dwordx4 v6, s[20:23], 0 offen nt lds
    s_add_u32 m0, s68, 1024
    s_nop 0
    buffer_load_dwordx4 v7, s[20:23], 0 offen nt lds
    s_add_u32 m0, s69, 0
    s_nop 0
    buffer_load_dwordx4 v8, s[20:23], 0 offen nt lds
    s_add_u32 m0, s69, 1024
    s_nop 0
    buffer_load_dwordx4 v9, s[20:23], 0 offen nt lds
    s_mov_b32 m0, 2048
    s_mov_b64 exec, 0xff
    buffer_load_dwordx4 v18, s[20:23], 0 offen nt lds
    s_mov_b64 exec, -1
    s_barrier
    s_waitcnt vmcnt(0)
    s_barrier
    ds_read_b64_tr_b16 v[32:33], v10 offset:0
    ds_read_b64_tr_b16 v[34:35], v12 offset:0
    ds_read_b64_tr_b16 v[36:37], v10 offset:8
    ds_read_b64_tr_b16 v[38:39], v12 offset:8
    ds_read_b64_tr_b16 v[40:41], v10 offset:2048
    ds_read_b64_tr_b16 v[42:43], v13 offset:0
    ds_read_b64_tr_b16 v[44:45], v10 offset:2056
    ds_read_b64_tr_b16 v[46:47], v13 offset:8
    ds_read_b64_tr_b16 v[48:49], v11 offset:0
    ds_read_b64_tr_b16 v[50:51], v14 offset:0
    ds_read_b64_tr_b16 v[52:53], v11 offset:8
    ds_read_b64_tr_b16 v[54:55], v14 offset:8
    ds_read_b64_tr_b16 v[56:57], v11 offset:2048
    ds_read_b64_tr_b16 v[58:59], v15 offset:0
    ds_read_b64_tr_b16 v[60:61], v11 offset:2056
    ds_read_b64_tr_b16 v[62:63], v15 offset:8
    s_waitcnt lgkmcnt(0)
    s_setprio 1
    v_mfma_f32_16x16x32_bf16 v[64:67], v[32:35], v[24:27], 0
    v_mfma_f32_16x16x32_bf16 v[68:71], v[36:39], v[24:27], 0
    v_mfma_f32_16x16x32_bf16 v[72:75], v[40:43], v[24:27], 0
    v_mfma_f32_16x16x32_bf16 v[76:79], v[44:47], v[24:27], 0
    v_mfma_f32_16x16x32_bf16 v[80:83], v[48:51], v[24:27], 0
    v_mfma_f32_16x16x32_bf16 v[84:87], v[52:55], v[24:27], 0
    v_mfma_f32_16x16x32_bf16 v[88:91], v[56:59], v[24:27], 0
    v_mfma_f32_16x16x32_bf16 v[92:95], v[60:63], v[24:27], 0
    s_setprio 0
    s_nop 7
    v_cvt_pk_bf16_f32 v96, v64, v65
    v_cvt_pk_bf16_f32 v97, v66, v67
    v_cvt_pk_bf16_f32 v98, v68, v69
    v_cvt_pk_bf16_f32 v99, v70, v71
    v_cvt_pk_bf16_f32 v100, v72, v73
    v_cvt_pk_bf16_f32 v101, v74, v75
    v_cvt_pk_bf16_f32 v102, v76, v77
    v_cvt_pk_bf16_f32 v103, v78, v79
    v_cvt_pk_bf16_f32 v104, v80, v81
    v_cvt_pk_bf16_f32 v105, v82, v83
    v_cvt_pk_bf16_f32 v106, v84, v85
    v_cvt_pk_bf16_f32 v107, v86, v87
    v_cvt_pk_bf16_f32 v108, v88, v89
    v_cvt_pk_bf16_f32 v109, v90, v91
    v_cvt_pk_bf16_f32 v110, v92, v93
    v_cvt_pk_bf16_f32 v111, v94, v95
    buffer_load_ushort v114, v113, s[16:19], 0 offen
    s_mov_b32 s16, s12
    s_mov_b32 s17, s13
    buffer_load_ushort v115, v113, s[16:19], 0 offen
    s_mov_b32 s62, 99
    v_mov_b32 v117, 0
    v_mov_b32 v118, 0
    s_cmp_lg_u32 s50, 3
    s_cbranch_scc1 L_noclean
    v_lshl_add_u32 v117, v0, 3, s49
    v_mov_b32 v118, -1
    v_mov_b32 v119, -1
    buffer_store_dwordx2 v[118:119], v117, s[32:35], 0 offen sc1
    s_and_b32 s62, s2, 3
    s_add_u32 s62, s62, 2
    s_lshl_b32 s56, s2, 5
    s_and_b32 s56, s56, 128
    v_mov_b32 v117, s56
    v_mov_b32 v118, 1
L_noclean:
    s_barrier
L_hloop:
    ds_write_b128 v16, v[96:99] offset:0
    ds_write_b128 v16, v[100:103] offset:2048
    ds_write_b128 v17, v[104:107] offset:0
    ds_write_b128 v17, v[108:111] offset:2048
    s_add_u32 m0, s66, 32896
    s_nop 0
    buffer_load_dwordx4 v2, s[20:23], s65 offen nt lds
    s_waitcnt lgkmcnt(0)
    s_barrier
    s_add_u32 m0, s66, 33920
    s_nop 0
    buffer_load_dwordx4 v3, s[20:23], s65 offen nt lds
    s_add_u32 m0, s67, 32896
    s_nop 0
    buffer_load_dwordx4 v4, s[20:23], s65 offen nt lds
    s_add_u32 m0, s67, 33920
    s_nop 0
    buffer_load_dwordx4 v5, s[20:23], s65 offen nt lds
    s_add_u32 m0, s68, 32896
    s_nop 0
    buffer_load_dwordx4 v6, s[20:23], s65 offen nt lds
    s_add_u32 m0, s68, 33920
    s_nop 0
    buffer_load_dwordx4 v7, s[20:23], s65 offen nt lds
    s_waitcnt vmcnt(7)
    s_barrier
    s_add_u32 m0, s69, 32896
    s_nop 0
    buffer_load_dwordx4 v8, s[20:23], s65 offen nt lds
    s_add_u32 m0, s69, 33920
    s_nop 0
    buffer_load_dwordx4 v9, s[20:23], s65 offen nt lds
    s_mov_b32 m0, 34944
    s_mov_b64 exec, 0xff
    buffer_load_dwordx4 v18, s[20:23], s65 offen nt lds
    s_mov_b64 exec, -1
    s_add_u32 m0, s59, 0
    s_mov_b32 s57, s64
    buffer_load_dwordx4 v1, s[24:27], s57 offen lds
    s_add_u32 m0, s59, 4096
    s_add_u32 s57, s57, 262144
    buffer_load_dwordx4 v1, s[24:27], s57 offen lds
    s_add_u32 m0, s59, 8192
    s_add_u32 s57, s57, 262144
    buffer_load_dwordx4 v1, s[24:27], s57 offen lds
    s_add_u32 m0, s59, 12288
    s_add_u32 s57, s57, 262144
    buffer_load_dwordx4 v1, s[24:27], s57 offen lds
    s_add_u32 m0, s59, 16384
    s_add_u32 s57, s57, 262144
    buffer_load_dwordx4 v1, s[24:27], s57 offen lds
    s_add_u32 m0, s59, 20480
    s_add_u32 s57, s57, 262144
    buffer_load_dwordx4 v1, s[24:27], s57 offen lds
    s_add_u32 m0, s59, 24576
    s_add_u32 s57, s57, 262144
    buffer_load_dwordx4 v1, s[24:27], s57 offen lds
    s_add_u32 m0, s59, 28672
    s_add_u32 s57, s57, 262144
    s_cmp_ge_u32 s64, 131072
    s_cbranch_scc1 L_t7_1
    buffer_load_dwordx4 v1, s[24:27], s57 offen lds
L_t7_1:
    s_add_u32 s64, s64, 16384
    s_mov_b32 s46, s9
    buffer_load_dword v116, v19, s[44:47], 0 offen
    s_mov_b32 s9, 0
    s_mov_b32 s46, s8
    s_add_u32 s65, s65, 128
    s_add_u32 s61, s61, 1
    s_waitcnt vmcnt(8)
    s_barrier
L_hb0:
    ds_read_b64_tr_b16 v[32:33], v10 offset:32896
    ds_read_b64_tr_b16 v[34:35], v12 offset:32896
    ds_read_b64_tr_b16 v[36:37], v10 offset:32904
    ds_read_b64_tr_b16 v[38:39], v12 offset:32904
    ds_read_b64_tr_b16 v[40:41], v10 offset:34944
    ds_read_b64_tr_b16 v[42:43], v13 offset:32896
    ds_read_b64_tr_b16 v[44:45], v10 offset:34952
    ds_read_b64_tr_b16 v[46:47], v13 offset:32904
    ds_read_b64_tr_b16 v[48:49], v11 offset:32896
    ds_read_b64_tr_b16 v[50:51], v14 offset:32896
    ds_read_b64_tr_b16 v[52:53], v11 offset:32904
    ds_read_b64_tr_b16 v[54:55], v14 offset:32904
    ds_read_b64_tr_b16 v[56:57], v11 offset:34944
    ds_read_b64_tr_b16 v[58:59], v15 offset:32896
    ds_read_b64_tr_b16 v[60:61], v11 offset:34952
    ds_read_b64_tr_b16 v[62:63], v15 offset:32904
    s_add_u32 m0, s59, 32768
    s_mov_b32 s57, s64
    buffer_load_dwordx4 v1, s[24:27], s57 offen lds
    s_add_u32 m0, s59, 36864
    s_add_u32 s57, s57, 262144
    buffer_load_dwordx4 v1, s[24:27], s57 offen lds
    s_add_u32 m0, s59, 40960
    s_add_u32 s57, s57, 262144
    buffer_load_dwordx4 v1, s[24:27], s57 offen lds
    s_waitcnt vmcnt(4)
    s_barrier
    s_add_u32 m0, s59, 45056
    s_add_u32 s57, s57, 262144
    buffer_load_dwordx4 v1, s[24:27], s57 offen lds
    s_add_u32 m0, s59, 49152
    s_add_u32 s57, s57, 262144
    buffer_load_dwordx4 v1, s[24:27], s57 offen lds
    s_add_u32 m0, s59, 53248
    s_add_u32 s57, s57, 262144
    buffer_load_dwordx4 v1, s[24:27], s57 offen lds
    s_add_u32 m0, s59, 57344
    s_add_u32 s57, s57, 262144
    buffer_load_dwordx4 v1, s[24:27], s57 offen lds
    s_add_u32 m0, s59, 61440
    s_add_u32 s57, s57, 262144
    s_cmp_ge_u32 s64, 131072
    s_cbranch_scc1 L_t7_2
    buffer_load_dwordx4 v1, s[24:27], s57 offen lds
L_t7_2:
    s_add_u32 s64, s64, 16384
    buffer_load_dword v116, v19, s[44:47], 0 offen
    v_add_u32 v19, s63, v19
    s_mov_b32 s46, s8
    s_cmp_lg_u32 s61, s62
    s_cbranch_scc1 L_nocnt0
    s_mov_b64 exec, 1
    buffer_atomic_add v118, v117, s[36:39], 0 offen sc1
    s_mov_b64 exec, -1
L_nocnt0:
    s_waitcnt lgkmcnt(0)
    s_setprio 1
    v_mfma_f32_16x16x32_bf16 v[64:67], v[32:35], v[24:27], 0
    v_mfma_f32_16x16x32_bf16 v[68:71], v[36:39], v[24:27], 0
    v_mfma_f32_16x16x32_bf16 v[72:75], v[40:43], v[24:27], 0
    v_mfma_f32_16x16x32_bf16 v[76:79], v[44:47], v[24:27], 0
    v_mfma_f32_16x16x32_bf16 v[80:83], v[48:51], v[24:27], 0
    v_mfma_f32_16x16x32_bf16 v[84:87], v[52:55], v[24:27], 0
    v_mfma_f32_16x16x32_bf16 v[88:91], v[56:59], v[24:27], 0
    v_mfma_f32_16x16x32_bf16 v[92:95], v[60:63], v[24:27], 0
    s_setprio 0
    s_nop 7
    v_cvt_pk_bf16_f32 v96, v64, v65
    v_cvt_pk_bf16_f32 v97, v66, v67
    v_cvt_pk_bf16_f32 v98, v68, v69
    v_cvt_pk_bf16_f32 v99, v70, v71
    v_cvt_pk_bf16_f32 v100, v72, v73
    v_cvt_pk_bf16_f32 v101, v74, v75
    v_cvt_pk_bf16_f32 v102, v76, v77
    v_cvt_pk_bf16_f32 v103, v78, v79
    v_cvt_pk_bf16_f32 v104, v80, v81
    v_cvt_pk_bf16_f32 v105, v82, v83
    v_cvt_pk_bf16_f32 v106, v84, v85
    v_cvt_pk_bf16_f32 v107, v86, v87
    v_cvt_pk_bf16_f32 v108, v88, v89
    v_cvt_pk_bf16_f32 v109, v90, v91
    v_cvt_pk_bf16_f32 v110, v92, v93
    v_cvt_pk_bf16_f32 v111, v94, v95
    s_barrier
    s_cmp_eq_u32 s61, 7
    s_cbranch_scc1 L_hlast
    ds_write_b128 v16, v[96:99] offset:0
    ds_write_b128 v16, v[100:103] offset:2048
    ds_write_b128 v17, v[104:107] offset:0
    ds_write_b128 v17, v[108:111] offset:2048
    s_add_u32 m0, s66, 0
    s_nop 0
    buffer_load_dwordx4 v2, s[20:23], s65 offen nt lds
    s_waitcnt lgkmcnt(0)
    s_barrier
    s_add_u32 m0, s66, 1024
    s_nop 0
    buffer_load_dwordx4 v3, s[20:23], s65 offen nt lds
    s_add_u32 m0, s67, 0
    s_nop 0
    buffer_load_dwordx4 v4, s[20:23], s65 offen nt lds
    s_add_u32 m0, s67, 1024
    s_nop 0
    buffer_load_dwordx4 v5, s[20:23], s65 offen nt lds
    s_add_u32 m0, s68, 0
    s_nop 0
    buffer_load_dwordx4 v6, s[20:23], s65 offen nt lds
    s_add_u32 m0, s68, 1024
    s_nop 0
    buffer_load_dwordx4 v7, s[20:23], s65 offen nt lds
    s_waitcnt vmcnt(7)
    s_barrier
    s_add_u32 m0, s69, 0
    s_nop 0
    buffer_load_dwordx4 v8, s[20:23], s65 offen nt lds
    s_add_u32 m0, s69, 1024
    s_nop 0
    buffer_load_dwordx4 v9, s[20:23], s65 offen nt lds
    s_mov_b32 m0, 2048
    s_mov_b64 exec, 0xff
    buffer_load_dwordx4 v18, s[20:23], s65 offen nt lds
    s_mov_b64 exec, -1
    s_add_u32 m0, s59, 0
    s_mov_b32 s57, s64
    buffer_load_dwordx4 v1, s[24:27], s57 offen lds
    s_add_u32 m0, s59, 4096
    s_add_u32 s57, s57, 262144
    buffer_load_dwordx4 v1, s[24:27], s57 offen lds
    s_add_u32 m0, s59, 8192
    s_add_u32 s57, s57, 262144
    buffer_load_dwordx4 v1, s[24:27], s57 offen lds
    s_add_u32 m0, s59, 12288
    s_add_u32 s57, s57, 262144
    buffer_load_dwordx4 v1, s[24:27], s57 offen lds
    s_add_u32 m0, s59, 16384
    s_add_u32 s57, s57, 262144
    buffer_load_dwordx4 v1, s[24:27], s57 offen lds
    s_add_u32 m0, s59, 20480
    s_add_u32 s57, s57, 262144
    buffer_load_dwordx4 v1, s[24:27], s57 offen lds
    s_add_u32 m0, s59, 24576
    s_add_u32 s57, s57, 262144
    buffer_load_dwordx4 v1, s[24:27], s57 offen lds
    s_add_u32 m0, s59, 28672
    s_add_u32 s57, s57, 262144
    s_cmp_ge_u32 s64, 131072
    s_cbranch_scc1 L_t7_3
    buffer_load_dwordx4 v1, s[24:27], s57 offen lds
L_t7_3:
    s_add_u32 s64, s64, 16384
    s_mov_b32 s46, s9
    buffer_load_dword v116, v19, s[44:47], 0 offen
    s_mov_b32 s9, 0
    s_mov_b32 s46, s8
    s_add_u32 s65, s65, 128
    s_add_u32 s61, s61, 1
    s_waitcnt vmcnt(8)
    s_barrier
    ds_read_b64_tr_b16 v[32:33], v10 offset:0
    ds_read_b64_tr_b16 v[34:35], v12 offset:0
    ds_read_b64_tr_b16 v[36:37], v10 offset:8
    ds_read_b64_tr_b16 v[38:39], v12 offset:8
    ds_read_b64_tr_b16 v[40:41], v10 offset:2048
    ds_read_b64_tr_b16 v[42:43], v13 offset:0
    ds_read_b64_tr_b16 v[44:45], v10 offset:2056
    ds_read_b64_tr_b16 v[46:47], v13 offset:8
    ds_read_b64_tr_b16 v[48:49], v11 offset:0
    ds_read_b64_tr_b16 v[50:51], v14 offset:0
    ds_read_b64_tr_b16 v[52:53], v11 offset:8
    ds_read_b64_tr_b16 v[54:55], v14 offset:8
    ds_read_b64_tr_b16 v[56:57], v11 offset:2048
    ds_read_b64_tr_b16 v[58:59], v15 offset:0
    ds_read_b64_tr_b16 v[60:61], v11 offset:2056
    ds_read_b64_tr_b16 v[62:63], v15 offset:8
    s_add_u32 m0, s59, 32768
    s_mov_b32 s57, s64
    buffer_load_dwordx4 v1, s[24:27], s57 offen lds
    s_add_u32 m0, s59, 36864
    s_add_u32 s57, s57, 262144
    buffer_load_dwordx4 v1, s[24:27], s57 offen lds
    s_add_u32 m0, s59, 40960
    s_add_u32 s57, s57, 262144
    buffer_load_dwordx4 v1, s[24:27], s57 offen lds
    s_waitcnt vmcnt(4)
    s_barrier
    s_add_u32 m0, s59, 45056
    s_add_u32 s57, s57, 262144
    buffer_load_dwordx4 v1, s[24:27], s57 offen lds
    s_add_u32 m0, s59, 49152
    s_add_u32 s57, s57, 262144
    buffer_load_dwordx4 v1, s[24:27], s57 offen lds
    s_add_u32 m0, s59, 53248
    s_add_u32 s57, s57, 262144
    buffer_load_dwordx4 v1, s[24:27], s57 offen lds
    s_add_u32 m0, s59, 57344
    s_add_u32 s57, s57, 262144
    buffer_load_dwordx4 v1, s[24:27], s57 offen lds
    s_add_u32 m0, s59, 61440
    s_add_u32 s57, s57, 262144
    s_cmp_ge_u32 s64, 131072
    s_cbranch_scc1 L_t7_4
    buffer_load_dwordx4 v1, s[24:27], s57 offen lds
L_t7_4:
    s_add_u32 s64, s64, 16384
    buffer_load_dword v116, v19, s[44:47], 0 offen
    v_add_u32 v19, s63, v19
    s_mov_b32 s46, s8
    s_cmp_lg_u32 s61, s62
    s_cbranch_scc1 L_nocnt1
    s_mov_b64 exec, 1
    buffer_atomic_add v118, v117, s[36:39], 0 offen sc1
    s_mov_b64 exec, -1
L_nocnt1:
    s_waitcnt lgkmcnt(0)
    s_setprio 1
    v_mfma_f32_16x16x32_bf16 v[64:67], v[32:35], v[24:27], 0
    v_mfma_f32_16x16x32_bf16 v[68:71], v[36:39], v[24:27], 0
    v_mfma_f32_16x16x32_bf16 v[72:75], v[40:43], v[24:27], 0
    v_mfma_f32_16x16x32_bf16 v[76:79], v[44:47], v[24:27], 0
    v_mfma_f32_16x16x32_bf16 v[80:83], v[48:51], v[24:27], 0
    v_mfma_f32_16x16x32_bf16 v[84:87], v[52:55], v[24:27], 0
    v_mfma_f32_16x16x32_bf16 v[88:91], v[56:59], v[24:27], 0
    v_mfma_f32_16x16x32_bf16 v[92:95], v[60:63], v[24:27], 0
    s_setprio 0
    s_nop 7
    v_cvt_pk_bf16_f32 v96, v64, v65
    v_cvt_pk_bf16_f32 v97, v66, v67
    v_cvt_pk_bf16_f32 v98, v68, v69
    v_cvt_pk_bf16_f32 v99, v70, v71
    v_cvt_pk_bf16_f32 v100, v72, v73
    v_cvt_pk_bf16_f32 v101, v74, v75
    v_cvt_pk_bf16_f32 v102, v76, v77
    v_cvt_pk_bf16_f32 v103, v78, v79
    v_cvt_pk_bf16_f32 v104, v80, v81
    v_cvt_pk_bf16_f32 v105, v82, v83
    v_cvt_pk_bf16_f32 v106, v84, v85
    v_cvt_pk_bf16_f32 v107, v86, v87
    v_cvt_pk_bf16_f32 v108, v88, v89
    v_cvt_pk_bf16_f32 v109, v90, v91
    v_cvt_pk_bf16_f32 v110, v92, v93
    v_cvt_pk_bf16_f32 v111, v94, v95
    s_barrier
    s_branch L_hloop
L_chk_again:
    s_add_u32 s60, s60, 1
    s_cmp_ge_u32 s60, 0x100000
    s_cbranch_scc1 L_chk_ok
    buffer_load_dword v7, v8, s[36:39], 0 offen sc1
    s_branch L_chk
L_poll_again:
    buffer_load_dwordx4 v[128:131], v6, s[32:35], 0 offen sc1
    buffer_load_dwordx4 v[132:135], v6, s[32:35], s61 offen sc1
    buffer_load_dwordx4 v[136:139], v6, s[32:35], s62 offen sc1
    buffer_load_dwordx4 v[140:143], v6, s[32:35], s63 offen sc1
    s_add_u32 s60, s60, 1
    s_cmp_lt_u32 s60, 0x100000
    s_cbranch_scc1 L_poll
    s_waitcnt vmcnt(0)
    s_branch L_poll_ok
L_hlast:
    ds_write_b128 v16, v[96:99] offset:0
    ds_write_b128 v16, v[100:103] offset:2048
    ds_write_b128 v17, v[104:107] offset:0
    ds_write_b128 v17, v[108:111] offset:2048
    s_waitcnt lgkmcnt(0)
    s_barrier
    s_waitcnt vmcnt(0)
    s_barrier
    s_getpc_b64 s[44:45]
L_pc2:
    s_cmp_lt_u32 s50, 2
    s_cselect_b32 s56, L_pc2 - L_epi, 0
    s_cselect_b32 s46, L_helper - L_epi, s46
    s_cbranch_scc1 L_pc3
    s_mov_b32 s46, L_end - L_pc2
L_pc3:
    s_sub_u32 s44, s44, s56
    s_subb_u32 s45, s45, 0
    s_and_b32 s56, s50, 1
    s_lshl_b32 s56, s56, 6
    v_lshl_add_u32 v9, v0, 7, s56
    buffer_load_dword v116, v9, s[44:47], 0 offen
    v_and_b32 v8, 1, v0
    v_lshlrev_b32 v8, 7, v8
    buffer_load_dword v7, v8, s[36:39], 0 offen sc1
    s_lshl_b32 s56, s50, 7
    s_add_u32 s56, s56, s48
    v_lshrrev_b32 v6, 3, v0
    v_lshlrev_b32 v6, 9, v6
    v_and_b32 v3, 7, v0
    v_lshl_add_u32 v6, v3, 4, v6
    v_add_u32 v6, s56, v6
    s_movk_i32 s61, 0x1000
    s_movk_i32 s62, 0x2000
    s_movk_i32 s63, 0x3000
    v_lshlrev_b32 v2, 2, v112
    v_add_u32 v2, 148096, v2
    s_mov_b32 s64, 0x3eeff558
    v_lshlrev_b32 v114, 16, v114
    v_lshlrev_b32 v115, 16, v115
    v_mul_f32 v114, s64, v114
    v_mul_f32 v115, s64, v115
    s_mov_b32 s64, 0x39032fd1
    s_mov_b32 s4, 0xff
    s_mov_b32 s5, 0xff
    s_barrier
    s_barrier
    s_barrier
    s_mov_b32 s60, 0
L_chk:
    s_waitcnt vmcnt(0)
    v_cmp_gt_u32 vcc, 128, v7
    s_cbranch_vccnz L_chk_again
L_chk_ok:
    buffer_load_dwordx4 v[128:131], v6, s[32:35], 0 offen sc1
    buffer_load_dwordx4 v[132:135], v6, s[32:35], s61 offen sc1
    buffer_load_dwordx4 v[136:139], v6, s[32:35], s62 offen sc1
    buffer_load_dwordx4 v[140:143], v6, s[32:35], s63 offen sc1
    s_barrier
    v_lshrrev_b32 v20, 3, v0
    v_and_b32 v21, 7, v0
    v_lshrrev_b32 v22, 1, v20
    v_and_b32 v23, 1, v20
    v_lshl_add_u32 v22, v23, 4, v22
    v_mul_u32_u24 v22, 272, v22
    v_lshrrev_b32 v23, 1, v21
    v_mul_u32_u24 v23, 17472, v23
    v_add_u32 v22, v22, v23
    v_and_b32 v23, 1, v21
    v_lshl_add_u32 v22, v23, 5, v22
    s_and_b32 s56, s3, 1
    s_mul_i32 s56, s56, 8704
    s_lshr_b32 s57, s3, 1
    s_lshl_b32 s57, s57, 6
    s_add_u32 s56, s56, s57
    v_add_u32 v22, s56, v22
    ds_read_b128 v[64:67], v22 offset:0
    ds_read_b128 v[68:71], v22 offset:16
    ds_read_b128 v[72:75], v22 offset:1088
    ds_read_b128 v[76:79], v22 offset:1104
    ds_read_b128 v[80:83], v22 offset:2176
    ds_read_b128 v[84:87], v22 offset:2192
    ds_read_b128 v[88:91], v22 offset:3264
    ds_read_b128 v[92:95], v22 offset:3280
    s_lshl_b32 s56, s3, 5
    v_add_u32 v20, s56, v20
    v_lshlrev_b32 v23, 9, v20
    v_lshl_add_u32 v23, v21, 4, v23
    v_add_u32 v23, s51, v23
    v_lshlrev_b32 v24, 5, v21
    v_add_u32 v24, 148096, v24
    s_mov_b32 s66, 0xc09d30fc
    s_mov_b32 s67, s66
    s_mov_b32 s68, 0x3eeff558
    s_mov_b32 s69, s68
    s_mov_b32 s60, 0
L_poll:
    s_waitcnt vmcnt(0)
    v_or3_b32 v14, v129, v131, v133
    v_or3_b32 v15, v135, v137, v139
    v_or3_b32 v14, v14, v141, v143
    v_or_b32 v14, v14, v15
    v_cmp_gt_i32 vcc, 0, v14
    s_cbranch_vccnz L_poll_again
L_poll_ok:
    v_pk_add_f32 v[192:193], v[128:129], v[132:133]
    v_pk_add_f32 v[194:195], v[130:131], v[134:135]
    v_pk_add_f32 v[196:197], v[136:137], v[140:141]
    v_pk_add_f32 v[198:199], v[138:139], v[142:143]
    v_pk_add_f32 v[192:193], v[192:193], v[196:197]
    v_pk_add_f32 v[194:195], v[194:195], v[198:199]
    s_nop 1
    v_permlane32_swap_b32 v192, v194
    v_permlane32_swap_b32 v193, v195
    v_pk_add_f32 v[192:193], v[192:193], v[194:195]
    s_nop 1
    v_permlane16_swap_b32 v192, v193
    v_add_f32 v192, v192, v193
    s_nop 1
    v_add_f32_dpp v192, v192, v192 row_ror:8 row_mask:0xf bank_mask:0xf
    v_mul_f32 v192, s64, v192
    v_mov_b32 v193, v192
    s_nop 1
    v_permlane16_swap_b32 v192, v193
    v_fma_f32 v29, -v192, v192, v193
    v_max_f32 v29, 0, v29
    v_add_f32 v29, 0x3727c5ac, v29
    v_rsq_f32 v29, v29
    s_mov_b64 exec, s[4:5]
    v_mul_f32 v29, v114, v29
    v_fma_f32 v28, -v192, v29, v115
    ds_write2_b32 v2, v29, v28 offset0:0 offset1:64
    s_mov_b64 exec, -1
L_final:
    s_setprio 0
    s_waitcnt lgkmcnt(0)
    s_barrier
.p2align 3
L_gelu:
    ds_read_b128 v[32:35], v24
    ds_read_b128 v[40:43], v24 offset:256
    ds_read_b128 v[36:39], v24 offset:16
    ds_read_b128 v[44:47], v24 offset:272
    s_nop 0
    s_waitcnt lgkmcnt(2)
    v_pk_fma_f32 v[64:65], v[64:65], v[32:33], v[40:41]
    v_pk_fma_f32 v[66:67], v[66:67], v[34:35], v[42:43]
    s_waitcnt lgkmcnt(0)
    s_nop 0
    v_pk_fma_f32 v[68:69], v[68:69], v[36:37], v[44:45]
    v_pk_fma_f32 v[70:71], v[70:71], v[38:39], v[46:47]
    v_pk_fma_f32 v[96:97], v[64:65], v[64:65], s[66:67] neg_lo:[1,0,0] neg_hi:[1,0,0]
    v_pk_fma_f32 v[98:99], v[66:67], v[66:67], s[66:67] neg_lo:[1,0,0] neg_hi:[1,0,0]
    v_pk_fma_f32 v[100:101], v[68:69], v[68:69], s[66:67] neg_lo:[1,0,0] neg_hi:[1,0,0]
    v_pk_fma_f32 v[102:103], v[70:71], v[70:71], s[66:67] neg_lo:[1,0,0] neg_hi:[1,0,0]
    v_pk_mul_f32 v[96:97], v[96:97], v[64:65]
    v_pk_mul_f32 v[98:99], v[98:99], v[66:67]
    v_pk_mul_f32 v[100:101], v[100:101], v[68:69]
    v_pk_mul_f32 v[102:103], v[102:103], v[70:71]
    v_exp_f32 v96, v96
    v_exp_f32 v97, v97
    v_exp_f32 v98, v98
    v_exp_f32 v99, v99
    v_exp_f32 v100, v100
    v_exp_f32 v101, v101
    v_exp_f32 v102, v102
    v_exp_f32 v103, v103
    v_pk_fma_f32 v[96:97], v[96:97], s[68:69], s[68:69]
    v_pk_fma_f32 v[98:99], v[98:99], s[68:69], s[68:69]
    v_pk_fma_f32 v[100:101], v[100:101], s[68:69], s[68:69]
    v_pk_fma_f32 v[102:103], v[102:103], s[68:69], s[68:69]
    v_rcp_f32 v96, v96
    v_rcp_f32 v97, v97
    v_rcp_f32 v98, v98
    v_rcp_f32 v99, v99
    v_rcp_f32 v100, v100
    v_rcp_f32 v101, v101
    v_rcp_f32 v102, v102
    v_rcp_f32 v103, v103
    v_pk_mul_f32 v[64:65], v[64:65], v[96:97]
    v_pk_mul_f32 v[66:67], v[66:67], v[98:99]
    v_pk_mul_f32 v[68:69], v[68:69], v[100:101]
    v_pk_mul_f32 v[70:71], v[70:71], v[102:103]
    v_cvt_pk_bf16_f32 v48, v64, v65
    v_cvt_pk_bf16_f32 v49, v66, v67
    v_cvt_pk_bf16_f32 v50, v68, v69
    v_cvt_pk_bf16_f32 v51, v70, v71
    buffer_store_dwordx4 v[48:51], v23, s[28:31], 0 offen sc0 sc1
    v_add_u32 v23, 4096, v23
    v_pk_fma_f32 v[72:73], v[72:73], v[32:33], v[40:41]
    v_pk_fma_f32 v[74:75], v[74:75], v[34:35], v[42:43]
    v_pk_fma_f32 v[76:77], v[76:77], v[36:37], v[44:45]
    v_pk_fma_f32 v[78:79], v[78:79], v[38:39], v[46:47]
    v_pk_fma_f32 v[104:105], v[72:73], v[72:73], s[66:67] neg_lo:[1,0,0] neg_hi:[1,0,0]
    v_pk_fma_f32 v[106:107], v[74:75], v[74:75], s[66:67] neg_lo:[1,0,0] neg_hi:[1,0,0]
    v_pk_fma_f32 v[108:109], v[76:77], v[76:77], s[66:67] neg_lo:[1,0,0] neg_hi:[1,0,0]
    v_pk_fma_f32 v[110:111], v[78:79], v[78:79], s[66:67] neg_lo:[1,0,0] neg_hi:[1,0,0]
    v_pk_mul_f32 v[104:105], v[104:105], v[72:73]
    v_pk_mul_f32 v[106:107], v[106:107], v[74:75]
    v_pk_mul_f32 v[108:109], v[108:109], v[76:77]
    v_pk_mul_f32 v[110:111], v[110:111], v[78:79]
    v_exp_f32 v104, v104
    v_exp_f32 v105, v105
    v_exp_f32 v106, v106
    v_exp_f32 v107, v107
    v_exp_f32 v108, v108
    v_exp_f32 v109, v109
    v_exp_f32 v110, v110
    v_exp_f32 v111, v111
    v_pk_fma_f32 v[104:105], v[104:105], s[68:69], s[68:69]
    v_pk_fma_f32 v[106:107], v[106:107], s[68:69], s[68:69]
    v_pk_fma_f32 v[108:109], v[108:109], s[68:69], s[68:69]
    v_pk_fma_f32 v[110:111], v[110:111], s[68:69], s[68:69]
    v_rcp_f32 v104, v104
    v_rcp_f32 v105, v105
    v_rcp_f32 v106, v106
    v_rcp_f32 v107, v107
    v_rcp_f32 v108, v108
    v_rcp_f32 v109, v109
    v_rcp_f32 v110, v110
    v_rcp_f32 v111, v111
    v_pk_mul_f32 v[72:73], v[72:73], v[104:105]
    v_pk_mul_f32 v[74:75], v[74:75], v[106:107]
    v_pk_mul_f32 v[76:77], v[76:77], v[108:109]
    v_pk_mul_f32 v[78:79], v[78:79], v[110:111]
    v_cvt_pk_bf16_f32 v52, v72, v73
    v_cvt_pk_bf16_f32 v53, v74, v75
    v_cvt_pk_bf16_f32 v54, v76, v77
    v_cvt_pk_bf16_f32 v55, v78, v79
    buffer_store_dwordx4 v[52:55], v23, s[28:31], 0 offen sc0 sc1
    v_add_u32 v23, 4096, v23
    v_pk_fma_f32 v[80:81], v[80:81], v[32:33], v[40:41]
    v_pk_fma_f32 v[82:83], v[82:83], v[34:35], v[42:43]
    v_pk_fma_f32 v[84:85], v[84:85], v[36:37], v[44:45]
    v_pk_fma_f32 v[86:87], v[86:87], v[38:39], v[46:47]
    v_pk_fma_f32 v[112:113], v[80:81], v[80:81], s[66:67] neg_lo:[1,0,0] neg_hi:[1,0,0]
    v_pk_fma_f32 v[114:115], v[82:83], v[82:83], s[66:67] neg_lo:[1,0,0] neg_hi:[1,0,0]
    v_pk_fma_f32 v[116:117], v[84:85], v[84:85], s[66:67] neg_lo:[1,0,0] neg_hi:[1,0,0]
    v_pk_fma_f32 v[118:119], v[86:87], v[86:87], s[66:67] neg_lo:[1,0,0] neg_hi:[1,0,0]
    v_pk_mul_f32 v[112:113], v[112:113], v[80:81]
    v_pk_mul_f32 v[114:115], v[114:115], v[82:83]
    v_pk_mul_f32 v[116:117], v[116:117], v[84:85]
    v_pk_mul_f32 v[118:119], v[118:119], v[86:87]
    v_exp_f32 v112, v112
    v_exp_f32 v113, v113
    v_exp_f32 v114, v114
    v_exp_f32 v115, v115
    v_exp_f32 v116, v116
    v_exp_f32 v117, v117
    v_exp_f32 v118, v118
    v_exp_f32 v119, v119
    v_pk_fma_f32 v[112:113], v[112:113], s[68:69], s[68:69]
    v_pk_fma_f32 v[114:115], v[114:115], s[68:69], s[68:69]
    v_pk_fma_f32 v[116:117], v[116:117], s[68:69], s[68:69]
    v_pk_fma_f32 v[118:119], v[118:119], s[68:69], s[68:69]
    v_rcp_f32 v112, v112
    v_rcp_f32 v113, v113
    v_rcp_f32 v114, v114
    v_rcp_f32 v115, v115
    v_rcp_f32 v116, v116
    v_rcp_f32 v117, v117
    v_rcp_f32 v118, v118
    v_rcp_f32 v119, v119
    v_pk_mul_f32 v[80:81], v[80:81], v[112:113]
    v_pk_mul_f32 v[82:83], v[82:83], v[114:115]
    v_pk_mul_f32 v[84:85], v[84:85], v[116:117]
    v_pk_mul_f32 v[86:87], v[86:87], v[118:119]
    v_cvt_pk_bf16_f32 v56, v80, v81
    v_cvt_pk_bf16_f32 v57, v82, v83
    v_cvt_pk_bf16_f32 v58, v84, v85
    v_cvt_pk_bf16_f32 v59, v86, v87
    buffer_store_dwordx4 v[56:59], v23, s[28:31], 0 offen sc0 sc1
    v_add_u32 v23, 4096, v23
    v_pk_fma_f32 v[88:89], v[88:89], v[32:33], v[40:41]
    v_pk_fma_f32 v[90:91], v[90:91], v[34:35], v[42:43]
    v_pk_fma_f32 v[92:93], v[92:93], v[36:37], v[44:45]
    v_pk_fma_f32 v[94:95], v[94:95], v[38:39], v[46:47]
    v_pk_fma_f32 v[120:121], v[88:89], v[88:89], s[66:67] neg_lo:[1,0,0] neg_hi:[1,0,0]
    v_pk_fma_f32 v[122:123], v[90:91], v[90:91], s[66:67] neg_lo:[1,0,0] neg_hi:[1,0,0]
    v_pk_fma_f32 v[124:125], v[92:93], v[92:93], s[66:67] neg_lo:[1,0,0] neg_hi:[1,0,0]
    v_pk_fma_f32 v[126:127], v[94:95], v[94:95], s[66:67] neg_lo:[1,0,0] neg_hi:[1,0,0]
    v_pk_mul_f32 v[120:121], v[120:121], v[88:89]
    v_pk_mul_f32 v[122:123], v[122:123], v[90:91]
    v_pk_mul_f32 v[124:125], v[124:125], v[92:93]
    v_pk_mul_f32 v[126:127], v[126:127], v[94:95]
    v_exp_f32 v120, v120
    v_exp_f32 v121, v121
    v_exp_f32 v122, v122
    v_exp_f32 v123, v123
    v_exp_f32 v124, v124
    v_exp_f32 v125, v125
    v_exp_f32 v126, v126
    v_exp_f32 v127, v127
    v_pk_fma_f32 v[120:121], v[120:121], s[68:69], s[68:69]
    v_pk_fma_f32 v[122:123], v[122:123], s[68:69], s[68:69]
    v_pk_fma_f32 v[124:125], v[124:125], s[68:69], s[68:69]
    v_pk_fma_f32 v[126:127], v[126:127], s[68:69], s[68:69]
    v_rcp_f32 v120, v120
    v_rcp_f32 v121, v121
    v_rcp_f32 v122, v122
    v_rcp_f32 v123, v123
    v_rcp_f32 v124, v124
    v_rcp_f32 v125, v125
    v_rcp_f32 v126, v126
    v_rcp_f32 v127, v127
    v_pk_mul_f32 v[88:89], v[88:89], v[120:121]
    v_pk_mul_f32 v[90:91], v[90:91], v[122:123]
    v_pk_mul_f32 v[92:93], v[92:93], v[124:125]
    v_pk_mul_f32 v[94:95], v[94:95], v[126:127]
    v_cvt_pk_bf16_f32 v60, v88, v89
    v_cvt_pk_bf16_f32 v61, v90, v91
    v_cvt_pk_bf16_f32 v62, v92, v93
    v_cvt_pk_bf16_f32 v63, v94, v95
    buffer_store_dwordx4 v[60:63], v23, s[28:31], 0 offen sc0 sc1
L_end:
    s_endpgm
.section .rodata,"a"
.p2align 6
.amdhsa_kernel standalone__self_sup_conv_stem_hubert__speech_kernel
  .amdhsa_next_free_vgpr 256
  .amdhsa_next_free_sgpr 102
  .amdhsa_accum_offset 256
  .amdhsa_group_segment_fixed_size 0
  .amdhsa_kernarg_size 64
  .amdhsa_user_sgpr_count 2
  .amdhsa_user_sgpr_kernarg_segment_ptr 1
  .amdhsa_system_sgpr_workgroup_id_x 1
.end_amdhsa_kernel
```
